```python
import torch

def _softmax(x, axis=-1):
    return torch.softmax(x, dim=axis)
def _gelu(x):
    return torch.nn.functional.gelu(x, approximate="tanh")
def _silu(x):
    return torch.nn.functional.silu(x)
def _sigmoid(x):
    return torch.sigmoid(x)
def _layernorm(x, axis=-1, eps=1e-5):
    m = x.mean(dim=axis, keepdim=True)
    v = x.var(dim=axis, keepdim=True, unbiased=False)
    return (x - m) / torch.sqrt(v + eps)
def _scatter_add(tgt, idx, src, axis=0):
    return tgt.clone().index_add_(axis, idx, src)
def _segment_sum(src, seg, n):
    out = torch.zeros((n,) + src.shape[1:], dtype=src.dtype)
    return out.index_add_(0, seg, src)
def _pad(x, pw):
    flat = tuple(v for pair in reversed(pw) for v in pair)
    return torch.nn.functional.pad(x, flat)

kernel_name = 'standalone__edge_featured_mpnn_egc__graph'

def setup_inputs():

    _w = (lambda a: (lambda t: t.to(torch.bfloat16) if t.is_floating_point() else t)(torch.as_tensor(a)))
    N, deg, D, De = 25000, 16, 128, max(16, 1)
    E = N * deg
    return {
        "x": _w((lambda *s: torch.randn(*s, dtype=torch.bfloat16) * 0.2)(N, D)),
        "e_attr": _w((lambda *s: torch.randn(*s, dtype=torch.bfloat16) * 0.2)(E, De)),
        "src": _w((lambda lo, hi, *s: torch.randint(lo, hi, s))(0, N, E).to(torch.int64)),
        "dst": _w((lambda lo, hi, *s: torch.randint(lo, hi, s))(0, N, E).to(torch.int64)),
        "u_w": _w((lambda *s: torch.randn(*s, dtype=torch.bfloat16) * 0.05)(D, D)),
        "v_w": _w((lambda *s: torch.randn(*s, dtype=torch.bfloat16) * 0.05)(D, D)),
        "g_w": _w((lambda *s: torch.randn(*s, dtype=torch.bfloat16) * 0.2)(2 * D + De, D)),
    }

def reference(x, e_attr, src, dst, u_w, v_w, g_w):
    N, D = x.shape
    g_in = torch.concatenate([x[dst], x[src], e_attr], axis=-1)
    eta = _sigmoid(g_in @ g_w)
    hv = x @ v_w
    msg = eta * hv[src]
    agg = _segment_sum(msg, dst, N)
    return _silu(x @ u_w + agg)
```

```asm
; @launch grid=(256,1,1) block=(512,1,1) lds=163072
.amdgcn_target "amdgcn-amd-amdhsa--gfx950"
.text
.globl standalone__edge_featured_mpnn_egc__graph_kernel
.p2align 8
.type standalone__edge_featured_mpnn_egc__graph_kernel,@function
standalone__edge_featured_mpnn_egc__graph_kernel:
    s_cmp_ge_u32 s2, 256
    s_cbranch_scc1 K_END
    s_load_dwordx16 s[64:79], s[0:1], 0
    s_load_dwordx4 s[80:83], s[0:1], 64
    v_mov_b32 v250, v0
    v_lshrrev_b32 v1, 6, v0
    v_and_b32 v2, 63, v0
    v_readfirstlane_b32 s33, v1
    s_and_b32 s3, s2, 7
    s_lshl_b32 s3, s3, 5
    s_lshr_b32 s32, s2, 3
    s_add_u32 s32, s32, s3
    v_lshrrev_b32 v4, 4, v2
    s_mov_b32 s40, 0
    s_movk_i32 s41, 256
    s_mov_b32 s42, 1
    s_mov_b32 s58, 1
    s_mov_b32 s62, 4
    v_lshlrev_b32 v8, 2, v0
    v_add_u32 v8, 92160, v8
    v_mov_b32 v9, 0
    ds_write_b32 v8, v9
    ds_write_b32 v8, v9 offset:512
    v_lshlrev_b32 v8, 2, v2
    v_add_u32 v8, 162816, v8
    ds_write_b32 v8, v9
    s_mul_i32 s36, s32, 25088
    s_cmp_ge_u32 s33, 4
    s_cbranch_scc1 K_G
    s_cmp_lt_u32 s33, 2
    s_cbranch_scc1 K_NOCT
    v_and_b32 v241, 127, v0
    s_getpc_b64 s[34:35]
K_CT0:
    s_sub_u32 s34, s34, K_CT0-standalone__edge_featured_mpnn_egc__graph_kernel
    s_subb_u32 s35, s35, 0
    v_lshlrev_b32 v242, 7, v241
    global_load_dword v243, v242, s[34:35]
    v_add_u32 v242, 16384, v242
    global_load_dword v243, v242, s[34:35]
K_NOCT:
    s_mul_i32 s35, s33, 3200
    v_lshl_add_u32 v4, v2, 4, s35
    s_lshl_b32 s37, s33, 10
    s_add_u32 s37, s37, 92160
    v_mov_b32 v5, s37
    s_lshl_b32 s37, s33, 8
    s_add_u32 s37, s37, 92160
    v_mov_b32 v7, s37
    v_mov_b32 v6, 4
    v_cmp_gt_u32 s[56:57], 50, v2
    s_mul_i32 s39, s2, 6400
    s_waitcnt lgkmcnt(0)
    s_mov_b32 s20, s82
    s_mov_b32 s21, s83
    s_mov_b32 s22, 16777216
    s_mov_b32 s23, 0x20000
    s_cmp_eq_u32 s33, 3
    s_cbranch_scc1 K_S3
    s_cmp_ge_u32 s2, 250
    s_cbranch_scc1 K_PREP
    s_cmp_eq_u32 s33, 2
    s_cbranch_scc1 K_S2
    s_setprio 3
    s_add_u32 s24, s70, s39
    s_addc_u32 s25, s71, 0
    s_mov_b32 s26, 6400
    s_mov_b32 s27, 0x20000
    s_add_u32 s4, s68, s39
    s_addc_u32 s5, s69, 0
    s_mov_b32 s6, 6400
    s_mov_b32 s7, 0x20000
    s_mov_b64 exec, s[56:57]
    buffer_load_dwordx4 v[10:13], v4, s[24:27], 0 offen offset:0
    buffer_load_dwordx4 v[26:29], v4, s[4:7], 0 offen offset:0
    buffer_load_dwordx4 v[14:17], v4, s[24:27], 0 offen offset:800
    buffer_load_dwordx4 v[30:33], v4, s[4:7], 0 offen offset:800
    buffer_load_dwordx4 v[18:21], v4, s[24:27], 0 offen offset:1600
    buffer_load_dwordx4 v[34:37], v4, s[4:7], 0 offen offset:1600
    buffer_load_dwordx4 v[22:25], v4, s[24:27], 0 offen offset:2400
    buffer_load_dwordx4 v[38:41], v4, s[4:7], 0 offen offset:2400
    s_mov_b64 exec, -1
    s_barrier
    s_branch K_S01
K_S3:
    s_cmp_lg_u32 s2, 0
    s_cbranch_scc1 K_NONONCE
    s_memrealtime s[44:45]
    s_waitcnt lgkmcnt(0)
    s_or_b32 s44, s44, 1
    v_mov_b32 v8, s44
    s_mov_b64 exec, 1
    global_store_dword v9, v8, s[80:81] sc1
    s_mov_b64 exec, -1
K_NONONCE:
    s_barrier
    s_branch K_S3B
K_S2:
    s_add_u32 s24, s76, 32768
    s_addc_u32 s25, s77, 0
    s_mov_b32 s26, 32768
    s_mov_b32 s27, 0x20000
    s_bitcmp1_b32 s2, 7
    s_cselect_b32 s24, s74, s24
    s_cselect_b32 s25, s75, s25
    s_bfe_u32 s37, s2, 0x40003
    s_lshl_b32 s37, s37, 11
    v_lshlrev_b32 v22, 7, v2
    s_mov_b64 exec, 0xffff
    buffer_load_dword v23, v22, s[24:27], s37 offen
    s_mov_b64 exec, -1
    s_barrier
    s_branch K_S2B
K_G:
    s_and_b32 s34, s33, 3
    s_lshl_b32 s37, s34, 2
    v_add_u32 v8, s37, v4
    v_xor_b32 v10, v8, v2
    v_and_b32 v10, 15, v10
    v_lshlrev_b32 v10, 4, v10
    v_lshl_add_u32 v10, v8, 8, v10
    v_lshlrev_b32 v11, 2, v4
    v_xor_b32 v11, v11, v2
    v_and_b32 v11, 15, v11
    v_lshlrev_b32 v11, 4, v11
    v_lshl_add_u32 v11, v4, 8, v11
    v_and_b32 v12, 255, v0
    v_lshlrev_b32 v12, 4, v12
    s_mul_i32 s39, s2, 51200
    s_waitcnt lgkmcnt(0)
    s_add_u32 s24, s64, s36
    s_addc_u32 s25, s65, 0
    s_mov_b32 s26, 26624
    s_mov_b32 s27, 0x20000
    s_sub_u32 s38, 6400000, s36
    s_min_u32 s26, s26, s38
    s_add_u32 s4, s76, 32768
    s_addc_u32 s5, s77, 0
    s_mov_b32 s6, 32768
    s_mov_b32 s7, 0x20000
    s_mov_b32 s8, s74
    s_mov_b32 s9, s75
    s_mov_b32 s10, 32768
    s_mov_b32 s11, 0x20000
    s_mov_b32 s20, s82
    s_mov_b32 s21, s83
    s_mov_b32 s22, 16777216
    s_mov_b32 s23, 0x20000
    s_lshl_b32 s35, s34, 10
    s_add_u32 s38, s35, 65536
    s_lshl_b32 s37, s34, 13
    s_barrier
    s_add_u32 m0, s38, 0
    s_nop 0
    buffer_load_dwordx4 v10, s[24:27], 0 offen lds
    s_add_u32 m0, s38, 4096
    v_add_u32 v10, 4096, v10
    buffer_load_dwordx4 v10, s[24:27], 0 offen lds
    s_add_u32 m0, s38, 8192
    v_add_u32 v10, 4096, v10
    buffer_load_dwordx4 v10, s[24:27], 0 offen lds
    s_add_u32 m0, s38, 12288
    v_add_u32 v10, 4096, v10
    buffer_load_dwordx4 v10, s[24:27], 0 offen lds
    s_add_u32 m0, s38, 16384
    v_add_u32 v10, 4096, v10
    buffer_load_dwordx4 v10, s[24:27], 0 offen lds
    s_add_u32 m0, s38, 20480
    v_add_u32 v10, 4096, v10
    buffer_load_dwordx4 v10, s[24:27], 0 offen lds
    s_add_u32 s38, s38, 24576
    s_cmp_lt_u32 s34, 2
    s_cselect_b32 m0, s38, 161792
    v_add_u32 v10, 4096, v10
    buffer_load_dwordx4 v10, s[24:27], 0 offen lds
    v_mov_b32 v14, 162816
    v_mov_b32 v15, 1
    s_mov_b64 exec, 1
    ds_add_u32 v14, v15 offset:40
    s_mov_b64 exec, -1
    s_add_u32 m0, s37, 0
    s_add_u32 s44, s37, 0
    buffer_load_dwordx4 v11, s[4:7], s44 offen offset:0 lds
    buffer_load_dwordx4 v11, s[4:7], s44 offen offset:1024 lds
    buffer_load_dwordx4 v11, s[4:7], s44 offen offset:2048 lds
    buffer_load_dwordx4 v11, s[4:7], s44 offen offset:3072 lds
    s_add_u32 m0, s37, 4096
    s_add_u32 s44, s37, 4096
    buffer_load_dwordx4 v11, s[4:7], s44 offen offset:0 lds
    buffer_load_dwordx4 v11, s[4:7], s44 offen offset:1024 lds
    buffer_load_dwordx4 v11, s[4:7], s44 offen offset:2048 lds
    buffer_load_dwordx4 v11, s[4:7], s44 offen offset:3072 lds
    s_add_u32 m0, s37, 32768
    s_add_u32 s44, s37, 0
    buffer_load_dwordx4 v11, s[8:11], s44 offen offset:0 lds
    buffer_load_dwordx4 v11, s[8:11], s44 offen offset:1024 lds
    buffer_load_dwordx4 v11, s[8:11], s44 offen offset:2048 lds
    buffer_load_dwordx4 v11, s[8:11], s44 offen offset:3072 lds
    s_add_u32 m0, s37, 36864
    s_add_u32 s44, s37, 4096
    buffer_load_dwordx4 v11, s[8:11], s44 offen offset:0 lds
    buffer_load_dwordx4 v11, s[8:11], s44 offen offset:1024 lds
    buffer_load_dwordx4 v11, s[8:11], s44 offen offset:2048 lds
    buffer_load_dwordx4 v11, s[8:11], s44 offen offset:3072 lds
    s_branch K_G2
K_S2B:
    s_mul_i32 s39, s2, 51200
    s_add_u32 s8, s66, s39
    s_addc_u32 s9, s67, 0
    s_mov_b32 s10, 51200
    s_mov_b32 s11, 0x20000
    v_lshlrev_b32 v22, 4, v2
    v_mov_b32 v30, 162816
    s_mov_b32 s38, 524288
K_WX2:
    ds_read_b32 v31, v30 offset:40
    s_waitcnt lgkmcnt(0)
    v_readfirstlane_b32 s37, v31
    s_cmp_ge_u32 s37, 4
    s_cbranch_scc1 K_WX2_OK
    s_sleep 1
    s_sub_u32 s38, s38, 1
    s_cmp_lg_u32 s38, 0
    s_cbranch_scc1 K_WX2
K_WX2_OK:
    s_nop 1
    s_mov_b32 m0, 110080
    s_mov_b32 s37, 0
    buffer_load_dwordx4 v22, s[8:11], s37 offen offset:0 lds
    buffer_load_dwordx4 v22, s[8:11], s37 offen offset:1024 lds
    buffer_load_dwordx4 v22, s[8:11], s37 offen offset:2048 lds
    buffer_load_dwordx4 v22, s[8:11], s37 offen offset:3072 lds
    s_mov_b32 m0, 114176
    s_mov_b32 s37, 4096
    buffer_load_dwordx4 v22, s[8:11], s37 offen offset:0 lds
    buffer_load_dwordx4 v22, s[8:11], s37 offen offset:1024 lds
    buffer_load_dwordx4 v22, s[8:11], s37 offen offset:2048 lds
    buffer_load_dwordx4 v22, s[8:11], s37 offen offset:3072 lds
    s_mov_b32 m0, 118272
    s_mov_b32 s37, 8192
    buffer_load_dwordx4 v22, s[8:11], s37 offen offset:0 lds
    buffer_load_dwordx4 v22, s[8:11], s37 offen offset:1024 lds
    buffer_load_dwordx4 v22, s[8:11], s37 offen offset:2048 lds
    buffer_load_dwordx4 v22, s[8:11], s37 offen offset:3072 lds
    s_mov_b32 m0, 122368
    s_mov_b32 s37, 12288
    buffer_load_dwordx4 v22, s[8:11], s37 offen offset:0 lds
    buffer_load_dwordx4 v22, s[8:11], s37 offen offset:1024 lds
    buffer_load_dwordx4 v22, s[8:11], s37 offen offset:2048 lds
    buffer_load_dwordx4 v22, s[8:11], s37 offen offset:3072 lds
    v_mov_b32 v30, 162816
    s_mov_b32 s38, 524288
K_WX2H:
    ds_read_b32 v31, v30 offset:56
    s_waitcnt lgkmcnt(0)
    v_readfirstlane_b32 s37, v31
    s_cmp_ge_u32 s37, 2
    s_cbranch_scc1 K_WX2H_OK
    s_sleep 1
    s_sub_u32 s38, s38, 1
    s_cmp_lg_u32 s38, 0
    s_cbranch_scc1 K_WX2H
K_WX2H_OK:
    s_nop 1
    s_mov_b32 m0, 126464
    s_mov_b32 s37, 16384
    buffer_load_dwordx4 v22, s[8:11], s37 offen offset:0 lds
    buffer_load_dwordx4 v22, s[8:11], s37 offen offset:1024 lds
    buffer_load_dwordx4 v22, s[8:11], s37 offen offset:2048 lds
    buffer_load_dwordx4 v22, s[8:11], s37 offen offset:3072 lds
    s_mov_b32 m0, 130560
    s_mov_b32 s37, 20480
    buffer_load_dwordx4 v22, s[8:11], s37 offen offset:0 lds
    buffer_load_dwordx4 v22, s[8:11], s37 offen offset:1024 lds
    buffer_load_dwordx4 v22, s[8:11], s37 offen offset:2048 lds
    buffer_load_dwordx4 v22, s[8:11], s37 offen offset:3072 lds
    s_mov_b32 m0, 134656
    s_mov_b32 s37, 24576
    buffer_load_dwordx4 v22, s[8:11], s37 offen offset:0 lds
    s_waitcnt vmcnt(0)
    v_mov_b32 v30, 162816
    v_mov_b32 v31, 1
    s_mov_b64 exec, 1
    ds_add_u32 v30, v31 offset:48
    s_mov_b64 exec, -1
    v_mov_b32 v30, 162816
    v_mov_b32 v31, 1
    s_mov_b64 exec, 1
    ds_add_u32 v30, v31 offset:12
    s_mov_b64 exec, -1
    s_branch K_W1
K_S01:
    s_add_u32 s39, s39, 13631488
    s_add_u32 s8, s82, s39
    s_addc_u32 s9, s83, 0
    s_mov_b32 s10, 6400
    s_mov_b32 s11, 0x20000
    s_lshl_b32 s39, s2, 11
    s_add_u32 s39, s39, 15728640
    s_add_u32 s28, s82, s39
    s_addc_u32 s29, s83, 0
    s_mov_b32 s30, 2048
    s_mov_b32 s31, 0x20000
    s_movk_i32 s39, 5352
    v_mov_b32 v109, 1338
    s_mov_b64 exec, s[56:57]
    s_waitcnt vmcnt(6)
    v_mul_u32_u24 v42, 5350, v10
    v_lshrrev_b32 v42, 19, v42
    v_lshrrev_b32 v108, 12, v26
    v_and_b32 v74, 0xe0, v42
    v_mul_u32_u24 v106, 98, v42
    v_lshl_add_u32 v42, v42, 2, v5
    ds_add_rtn_u32 v58, v42, v6 offset:0
    v_lshl_add_u32 v74, v108, 2, v74
    v_add_u32 v74, v74, v7
    ds_add_rtn_u32 v90, v74, v6 offset:2048
    v_sub_u32 v106, v10, v106
    v_mad_u32_u24 v107, v106, s39, v109
    v_lshrrev_b32 v107, 16, v107
    v_mad_u32_u24 v108, v107, 49, 2
    v_lshrrev_b32 v108, 2, v108
    v_sub_u32 v106, v106, v108
    v_lshlrev_b32 v107, 29, v107
    v_lshl_or_b32 v107, v26, 14, v107
    v_lshl_or_b32 v26, v106, 10, v107
    v_mul_u32_u24 v43, 5350, v11
    v_lshrrev_b32 v43, 19, v43
    v_lshrrev_b32 v108, 12, v27
    v_and_b32 v75, 0xe0, v43
    v_mul_u32_u24 v106, 98, v43
    v_lshl_add_u32 v43, v43, 2, v5
    ds_add_rtn_u32 v59, v43, v6 offset:0
    v_lshl_add_u32 v75, v108, 2, v75
    v_add_u32 v75, v75, v7
    ds_add_rtn_u32 v91, v75, v6 offset:2048
    v_sub_u32 v106, v11, v106
    v_mad_u32_u24 v107, v106, s39, v109
    v_lshrrev_b32 v107, 16, v107
    v_mad_u32_u24 v108, v107, 49, 2
    v_lshrrev_b32 v108, 2, v108
    v_sub_u32 v106, v106, v108
    v_lshlrev_b32 v107, 29, v107
    v_lshl_or_b32 v107, v27, 14, v107
    v_lshl_or_b32 v27, v106, 10, v107
    v_mul_u32_u24 v44, 5350, v12
    v_lshrrev_b32 v44, 19, v44
    v_lshrrev_b32 v108, 12, v28
    v_and_b32 v76, 0xe0, v44
    v_mul_u32_u24 v106, 98, v44
    v_lshl_add_u32 v44, v44, 2, v5
    ds_add_rtn_u32 v60, v44, v6 offset:0
    v_lshl_add_u32 v76, v108, 2, v76
    v_add_u32 v76, v76, v7
    ds_add_rtn_u32 v92, v76, v6 offset:2048
    v_sub_u32 v106, v12, v106
    v_mad_u32_u24 v107, v106, s39, v109
    v_lshrrev_b32 v107, 16, v107
    v_mad_u32_u24 v108, v107, 49, 2
    v_lshrrev_b32 v108, 2, v108
    v_sub_u32 v106, v106, v108
    v_lshlrev_b32 v107, 29, v107
    v_lshl_or_b32 v107, v28, 14, v107
    v_lshl_or_b32 v28, v106, 10, v107
    v_mul_u32_u24 v45, 5350, v13
    v_lshrrev_b32 v45, 19, v45
    v_lshrrev_b32 v108, 12, v29
    v_and_b32 v77, 0xe0, v45
    v_mul_u32_u24 v106, 98, v45
    v_lshl_add_u32 v45, v45, 2, v5
    ds_add_rtn_u32 v61, v45, v6 offset:0
    v_lshl_add_u32 v77, v108, 2, v77
    v_add_u32 v77, v77, v7
    ds_add_rtn_u32 v93, v77, v6 offset:2048
    v_sub_u32 v106, v13, v106
    v_mad_u32_u24 v107, v106, s39, v109
    v_lshrrev_b32 v107, 16, v107
    v_mad_u32_u24 v108, v107, 49, 2
    v_lshrrev_b32 v108, 2, v108
    v_sub_u32 v106, v106, v108
    v_lshlrev_b32 v107, 29, v107
    v_lshl_or_b32 v107, v29, 14, v107
    v_lshl_or_b32 v29, v106, 10, v107
    s_waitcnt vmcnt(4)
    v_mul_u32_u24 v46, 5350, v14
    v_lshrrev_b32 v46, 19, v46
    v_lshrrev_b32 v108, 12, v30
    v_and_b32 v78, 0xe0, v46
    v_mul_u32_u24 v106, 98, v46
    v_lshl_add_u32 v46, v46, 2, v5
    ds_add_rtn_u32 v62, v46, v6 offset:0
    v_lshl_add_u32 v78, v108, 2, v78
    v_add_u32 v78, v78, v7
    ds_add_rtn_u32 v94, v78, v6 offset:2048
    v_sub_u32 v106, v14, v106
    v_mad_u32_u24 v107, v106, s39, v109
    v_lshrrev_b32 v107, 16, v107
    v_mad_u32_u24 v108, v107, 49, 2
    v_lshrrev_b32 v108, 2, v108
    v_sub_u32 v106, v106, v108
    v_lshlrev_b32 v107, 29, v107
    v_lshl_or_b32 v107, v30, 14, v107
    v_lshl_or_b32 v30, v106, 10, v107
    v_mul_u32_u24 v47, 5350, v15
    v_lshrrev_b32 v47, 19, v47
    v_lshrrev_b32 v108, 12, v31
    v_and_b32 v79, 0xe0, v47
    v_mul_u32_u24 v106, 98, v47
    v_lshl_add_u32 v47, v47, 2, v5
    ds_add_rtn_u32 v63, v47, v6 offset:0
    v_lshl_add_u32 v79, v108, 2, v79
    v_add_u32 v79, v79, v7
    ds_add_rtn_u32 v95, v79, v6 offset:2048
    v_sub_u32 v106, v15, v106
    v_mad_u32_u24 v107, v106, s39, v109
    v_lshrrev_b32 v107, 16, v107
    v_mad_u32_u24 v108, v107, 49, 2
    v_lshrrev_b32 v108, 2, v108
    v_sub_u32 v106, v106, v108
    v_lshlrev_b32 v107, 29, v107
    v_lshl_or_b32 v107, v31, 14, v107
    v_lshl_or_b32 v31, v106, 10, v107
    v_mul_u32_u24 v48, 5350, v16
    v_lshrrev_b32 v48, 19, v48
    v_lshrrev_b32 v108, 12, v32
    v_and_b32 v80, 0xe0, v48
    v_mul_u32_u24 v106, 98, v48
    v_lshl_add_u32 v48, v48, 2, v5
    ds_add_rtn_u32 v64, v48, v6 offset:0
    v_lshl_add_u32 v80, v108, 2, v80
    v_add_u32 v80, v80, v7
    ds_add_rtn_u32 v96, v80, v6 offset:2048
    v_sub_u32 v106, v16, v106
    v_mad_u32_u24 v107, v106, s39, v109
    v_lshrrev_b32 v107, 16, v107
    v_mad_u32_u24 v108, v107, 49, 2
    v_lshrrev_b32 v108, 2, v108
    v_sub_u32 v106, v106, v108
    v_lshlrev_b32 v107, 29, v107
    v_lshl_or_b32 v107, v32, 14, v107
    v_lshl_or_b32 v32, v106, 10, v107
    v_mul_u32_u24 v49, 5350, v17
    v_lshrrev_b32 v49, 19, v49
    v_lshrrev_b32 v108, 12, v33
    v_and_b32 v81, 0xe0, v49
    v_mul_u32_u24 v106, 98, v49
    v_lshl_add_u32 v49, v49, 2, v5
    ds_add_rtn_u32 v65, v49, v6 offset:0
    v_lshl_add_u32 v81, v108, 2, v81
    v_add_u32 v81, v81, v7
    ds_add_rtn_u32 v97, v81, v6 offset:2048
    v_sub_u32 v106, v17, v106
    v_mad_u32_u24 v107, v106, s39, v109
    v_lshrrev_b32 v107, 16, v107
    v_mad_u32_u24 v108, v107, 49, 2
    v_lshrrev_b32 v108, 2, v108
    v_sub_u32 v106, v106, v108
    v_lshlrev_b32 v107, 29, v107
    v_lshl_or_b32 v107, v33, 14, v107
    v_lshl_or_b32 v33, v106, 10, v107
    s_waitcnt vmcnt(2)
    v_mul_u32_u24 v50, 5350, v18
    v_lshrrev_b32 v50, 19, v50
    v_lshrrev_b32 v108, 12, v34
    v_and_b32 v82, 0xe0, v50
    v_mul_u32_u24 v106, 98, v50
    v_lshl_add_u32 v50, v50, 2, v5
    ds_add_rtn_u32 v66, v50, v6 offset:0
    v_lshl_add_u32 v82, v108, 2, v82
    v_add_u32 v82, v82, v7
    ds_add_rtn_u32 v98, v82, v6 offset:2048
    v_sub_u32 v106, v18, v106
    v_mad_u32_u24 v107, v106, s39, v109
    v_lshrrev_b32 v107, 16, v107
    v_mad_u32_u24 v108, v107, 49, 2
    v_lshrrev_b32 v108, 2, v108
    v_sub_u32 v106, v106, v108
    v_lshlrev_b32 v107, 29, v107
    v_lshl_or_b32 v107, v34, 14, v107
    v_lshl_or_b32 v34, v106, 10, v107
    v_mul_u32_u24 v51, 5350, v19
    v_lshrrev_b32 v51, 19, v51
    v_lshrrev_b32 v108, 12, v35
    v_and_b32 v83, 0xe0, v51
    v_mul_u32_u24 v106, 98, v51
    v_lshl_add_u32 v51, v51, 2, v5
    ds_add_rtn_u32 v67, v51, v6 offset:0
    v_lshl_add_u32 v83, v108, 2, v83
    v_add_u32 v83, v83, v7
    ds_add_rtn_u32 v99, v83, v6 offset:2048
    v_sub_u32 v106, v19, v106
    v_mad_u32_u24 v107, v106, s39, v109
    v_lshrrev_b32 v107, 16, v107
    v_mad_u32_u24 v108, v107, 49, 2
    v_lshrrev_b32 v108, 2, v108
    v_sub_u32 v106, v106, v108
    v_lshlrev_b32 v107, 29, v107
    v_lshl_or_b32 v107, v35, 14, v107
    v_lshl_or_b32 v35, v106, 10, v107
    v_mul_u32_u24 v52, 5350, v20
    v_lshrrev_b32 v52, 19, v52
    v_lshrrev_b32 v108, 12, v36
    v_and_b32 v84, 0xe0, v52
    v_mul_u32_u24 v106, 98, v52
    v_lshl_add_u32 v52, v52, 2, v5
    ds_add_rtn_u32 v68, v52, v6 offset:0
    v_lshl_add_u32 v84, v108, 2, v84
    v_add_u32 v84, v84, v7
    ds_add_rtn_u32 v100, v84, v6 offset:2048
    v_sub_u32 v106, v20, v106
    v_mad_u32_u24 v107, v106, s39, v109
    v_lshrrev_b32 v107, 16, v107
    v_mad_u32_u24 v108, v107, 49, 2
    v_lshrrev_b32 v108, 2, v108
    v_sub_u32 v106, v106, v108
    v_lshlrev_b32 v107, 29, v107
    v_lshl_or_b32 v107, v36, 14, v107
    v_lshl_or_b32 v36, v106, 10, v107
    v_mul_u32_u24 v53, 5350, v21
    v_lshrrev_b32 v53, 19, v53
    v_lshrrev_b32 v108, 12, v37
    v_and_b32 v85, 0xe0, v53
    v_mul_u32_u24 v106, 98, v53
    v_lshl_add_u32 v53, v53, 2, v5
    ds_add_rtn_u32 v69, v53, v6 offset:0
    v_lshl_add_u32 v85, v108, 2, v85
    v_add_u32 v85, v85, v7
    ds_add_rtn_u32 v101, v85, v6 offset:2048
    v_sub_u32 v106, v21, v106
    v_mad_u32_u24 v107, v106, s39, v109
    v_lshrrev_b32 v107, 16, v107
    v_mad_u32_u24 v108, v107, 49, 2
    v_lshrrev_b32 v108, 2, v108
    v_sub_u32 v106, v106, v108
    v_lshlrev_b32 v107, 29, v107
    v_lshl_or_b32 v107, v37, 14, v107
    v_lshl_or_b32 v37, v106, 10, v107
    s_waitcnt vmcnt(0)
    v_mul_u32_u24 v54, 5350, v22
    v_lshrrev_b32 v54, 19, v54
    v_lshrrev_b32 v108, 12, v38
    v_and_b32 v86, 0xe0, v54
    v_mul_u32_u24 v106, 98, v54
    v_lshl_add_u32 v54, v54, 2, v5
    ds_add_rtn_u32 v70, v54, v6 offset:0
    v_lshl_add_u32 v86, v108, 2, v86
    v_add_u32 v86, v86, v7
    ds_add_rtn_u32 v102, v86, v6 offset:2048
    v_sub_u32 v106, v22, v106
    v_mad_u32_u24 v107, v106, s39, v109
    v_lshrrev_b32 v107, 16, v107
    v_mad_u32_u24 v108, v107, 49, 2
    v_lshrrev_b32 v108, 2, v108
    v_sub_u32 v106, v106, v108
    v_lshlrev_b32 v107, 29, v107
    v_lshl_or_b32 v107, v38, 14, v107
    v_lshl_or_b32 v38, v106, 10, v107
    v_mul_u32_u24 v55, 5350, v23
    v_lshrrev_b32 v55, 19, v55
    v_lshrrev_b32 v108, 12, v39
    v_and_b32 v87, 0xe0, v55
    v_mul_u32_u24 v106, 98, v55
    v_lshl_add_u32 v55, v55, 2, v5
    ds_add_rtn_u32 v71, v55, v6 offset:0
    v_lshl_add_u32 v87, v108, 2, v87
    v_add_u32 v87, v87, v7
    ds_add_rtn_u32 v103, v87, v6 offset:2048
    v_sub_u32 v106, v23, v106
    v_mad_u32_u24 v107, v106, s39, v109
    v_lshrrev_b32 v107, 16, v107
    v_mad_u32_u24 v108, v107, 49, 2
    v_lshrrev_b32 v108, 2, v108
    v_sub_u32 v106, v106, v108
    v_lshlrev_b32 v107, 29, v107
    v_lshl_or_b32 v107, v39, 14, v107
    v_lshl_or_b32 v39, v106, 10, v107
    v_mul_u32_u24 v56, 5350, v24
    v_lshrrev_b32 v56, 19, v56
    v_lshrrev_b32 v108, 12, v40
    v_and_b32 v88, 0xe0, v56
    v_mul_u32_u24 v106, 98, v56
    v_lshl_add_u32 v56, v56, 2, v5
    ds_add_rtn_u32 v72, v56, v6 offset:0
    v_lshl_add_u32 v88, v108, 2, v88
    v_add_u32 v88, v88, v7
    ds_add_rtn_u32 v104, v88, v6 offset:2048
    v_sub_u32 v106, v24, v106
    v_mad_u32_u24 v107, v106, s39, v109
    v_lshrrev_b32 v107, 16, v107
    v_mad_u32_u24 v108, v107, 49, 2
    v_lshrrev_b32 v108, 2, v108
    v_sub_u32 v106, v106, v108
    v_lshlrev_b32 v107, 29, v107
    v_lshl_or_b32 v107, v40, 14, v107
    v_lshl_or_b32 v40, v106, 10, v107
    v_mul_u32_u24 v57, 5350, v25
    v_lshrrev_b32 v57, 19, v57
    v_lshrrev_b32 v108, 12, v41
    v_and_b32 v89, 0xe0, v57
    v_mul_u32_u24 v106, 98, v57
    v_lshl_add_u32 v57, v57, 2, v5
    ds_add_rtn_u32 v73, v57, v6 offset:0
    v_lshl_add_u32 v89, v108, 2, v89
    v_add_u32 v89, v89, v7
    ds_add_rtn_u32 v105, v89, v6 offset:2048
    v_sub_u32 v106, v25, v106
    v_mad_u32_u24 v107, v106, s39, v109
    v_lshrrev_b32 v107, 16, v107
    v_mad_u32_u24 v108, v107, 49, 2
    v_lshrrev_b32 v108, 2, v108
    v_sub_u32 v106, v106, v108
    v_lshlrev_b32 v107, 29, v107
    v_lshl_or_b32 v107, v41, 14, v107
    v_lshl_or_b32 v41, v106, 10, v107
    s_mov_b64 exec, -1
    v_lshl_add_u32 v10, v2, 4, v5
    v_lshl_add_u32 v11, v2, 2, v7
    ds_read_b128 v[12:15], v10 offset:0
    ds_read_b32 v20, v11 offset:2048
    s_waitcnt lgkmcnt(0)
    v_add_u32 v13, v13, v12
    v_add_u32 v14, v14, v13
    v_add_u32 v15, v15, v14
    v_mov_b32 v16, v15
    v_mov_b32 v21, v20
    s_nop 0
    v_add_u32_dpp v16, v16, v16 row_shr:1 row_mask:0xf bank_mask:0xf
    v_add_u32_dpp v21, v21, v21 row_shr:1 row_mask:0xf bank_mask:0xf
    s_nop 0
    v_add_u32_dpp v16, v16, v16 row_shr:2 row_mask:0xf bank_mask:0xf
    v_add_u32_dpp v21, v21, v21 row_shr:2 row_mask:0xf bank_mask:0xf
    s_nop 0
    v_add_u32_dpp v16, v16, v16 row_shr:4 row_mask:0xf bank_mask:0xf
    v_add_u32_dpp v21, v21, v21 row_shr:4 row_mask:0xf bank_mask:0xf
    s_nop 0
    v_add_u32_dpp v16, v16, v16 row_shr:8 row_mask:0xf bank_mask:0xf
    v_add_u32_dpp v21, v21, v21 row_shr:8 row_mask:0xf bank_mask:0xf
    s_nop 0
    v_add_u32_dpp v16, v16, v16 row_bcast:15 row_mask:0xa bank_mask:0xf
    v_add_u32_dpp v21, v21, v21 row_bcast:15 row_mask:0xa bank_mask:0xf
    s_nop 0
    v_add_u32_dpp v16, v16, v16 row_bcast:31 row_mask:0xc bank_mask:0xf
    v_add_u32_dpp v21, v21, v21 row_bcast:31 row_mask:0xc bank_mask:0xf
    s_nop 0
    v_sub_u32 v16, v16, v15
    v_sub_u32 v21, v21, v20
    v_add_u32 v17, v16, v12
    v_add_u32 v18, v16, v13
    v_add_u32 v19, v16, v14
    ds_write_b128 v10, v[16:19] offset:0
    ds_write_b32 v11, v21 offset:2048
    s_mov_b64 exec, s[56:57]
    ds_read_b32 v42, v42 offset:0
    ds_read_b32 v74, v74 offset:2048
    ds_read_b32 v43, v43 offset:0
    ds_read_b32 v75, v75 offset:2048
    ds_read_b32 v44, v44 offset:0
    ds_read_b32 v76, v76 offset:2048
    ds_read_b32 v45, v45 offset:0
    ds_read_b32 v77, v77 offset:2048
    ds_read_b32 v46, v46 offset:0
    ds_read_b32 v78, v78 offset:2048
    ds_read_b32 v47, v47 offset:0
    ds_read_b32 v79, v79 offset:2048
    ds_read_b32 v48, v48 offset:0
    ds_read_b32 v80, v80 offset:2048
    ds_read_b32 v49, v49 offset:0
    ds_read_b32 v81, v81 offset:2048
    ds_read_b32 v50, v50 offset:0
    ds_read_b32 v82, v82 offset:2048
    ds_read_b32 v51, v51 offset:0
    ds_read_b32 v83, v83 offset:2048
    ds_read_b32 v52, v52 offset:0
    ds_read_b32 v84, v84 offset:2048
    ds_read_b32 v53, v53 offset:0
    ds_read_b32 v85, v85 offset:2048
    ds_read_b32 v54, v54 offset:0
    ds_read_b32 v86, v86 offset:2048
    ds_read_b32 v55, v55 offset:0
    ds_read_b32 v87, v87 offset:2048
    ds_read_b32 v56, v56 offset:0
    ds_read_b32 v88, v88 offset:2048
    ds_read_b32 v57, v57 offset:0
    ds_read_b32 v89, v89 offset:2048
    s_mov_b64 exec, -1
    v_add_u32 v25, v16, v15
    v_lshl_or_b32 v22, v17, 16, v16
    v_lshl_or_b32 v23, v18, 16, v17
    v_lshl_or_b32 v24, v19, 16, v18
    v_lshl_or_b32 v25, v25, 16, v19
    v_subrev_u32 v10, 92160, v10
    s_add_u32 s35, s35, 92160
    v_lshlrev_b32 v106, 3, v4
    v_add_u32 v110, 92160, v4
    s_mov_b64 exec, s[56:57]
    s_waitcnt lgkmcnt(0)
    v_add_u32 v74, v74, v90
    v_add3_u32 v42, v42, v58, s35
    v_lshrrev_b32 v107, 2, v74
    v_add_u32 v74, s35, v74
    v_or_b32 v26, v26, v107
    v_add_u32 v108, 110080, v106
    ds_write_b32 v42, v26 offset:5120
    ds_write_b32 v74, v108 offset:11520
    v_add_u32 v75, v75, v91
    v_add3_u32 v43, v43, v59, s35
    v_lshrrev_b32 v107, 2, v75
    v_add_u32 v75, s35, v75
    v_or_b32 v27, v27, v107
    v_add_u32 v108, 110112, v106
    ds_write_b32 v43, v27 offset:5120
    ds_write_b32 v75, v108 offset:11520
    v_add_u32 v76, v76, v92
    v_add3_u32 v44, v44, v60, s35
    v_lshrrev_b32 v107, 2, v76
    v_add_u32 v76, s35, v76
    v_or_b32 v28, v28, v107
    v_add_u32 v108, 110144, v106
    ds_write_b32 v44, v28 offset:5120
    ds_write_b32 v76, v108 offset:11520
    v_add_u32 v77, v77, v93
    v_add3_u32 v45, v45, v61, s35
    v_lshrrev_b32 v107, 2, v77
    v_add_u32 v77, s35, v77
    v_or_b32 v29, v29, v107
    v_add_u32 v108, 110176, v106
    ds_write_b32 v45, v29 offset:5120
    ds_write_b32 v77, v108 offset:11520
    v_add_u32 v78, v78, v94
    v_add3_u32 v46, v46, v62, s35
    v_lshrrev_b32 v107, 2, v78
    v_add_u32 v78, s35, v78
    v_or_b32 v30, v30, v107
    v_add_u32 v108, 116480, v106
    ds_write_b32 v46, v30 offset:5120
    ds_write_b32 v78, v108 offset:11520
    v_add_u32 v79, v79, v95
    v_add3_u32 v47, v47, v63, s35
    v_lshrrev_b32 v107, 2, v79
    v_add_u32 v79, s35, v79
    v_or_b32 v31, v31, v107
    v_add_u32 v108, 116512, v106
    ds_write_b32 v47, v31 offset:5120
    ds_write_b32 v79, v108 offset:11520
    v_add_u32 v80, v80, v96
    v_add3_u32 v48, v48, v64, s35
    v_lshrrev_b32 v107, 2, v80
    v_add_u32 v80, s35, v80
    v_or_b32 v32, v32, v107
    v_add_u32 v108, 116544, v106
    ds_write_b32 v48, v32 offset:5120
    ds_write_b32 v80, v108 offset:11520
    v_add_u32 v81, v81, v97
    v_add3_u32 v49, v49, v65, s35
    v_lshrrev_b32 v107, 2, v81
    v_add_u32 v81, s35, v81
    v_or_b32 v33, v33, v107
    v_add_u32 v108, 116576, v106
    ds_write_b32 v49, v33 offset:5120
    ds_write_b32 v81, v108 offset:11520
    v_add_u32 v82, v82, v98
    v_add3_u32 v50, v50, v66, s35
    v_lshrrev_b32 v107, 2, v82
    v_add_u32 v82, s35, v82
    v_or_b32 v34, v34, v107
    v_add_u32 v108, 122880, v106
    ds_write_b32 v50, v34 offset:5120
    ds_write_b32 v82, v108 offset:11520
    v_add_u32 v83, v83, v99
    v_add3_u32 v51, v51, v67, s35
    v_lshrrev_b32 v107, 2, v83
    v_add_u32 v83, s35, v83
    v_or_b32 v35, v35, v107
    v_add_u32 v108, 122912, v106
    ds_write_b32 v51, v35 offset:5120
    ds_write_b32 v83, v108 offset:11520
    v_add_u32 v84, v84, v100
    v_add3_u32 v52, v52, v68, s35
    v_lshrrev_b32 v107, 2, v84
    v_add_u32 v84, s35, v84
    v_or_b32 v36, v36, v107
    v_add_u32 v108, 122944, v106
    ds_write_b32 v52, v36 offset:5120
    ds_write_b32 v84, v108 offset:11520
    v_add_u32 v85, v85, v101
    v_add3_u32 v53, v53, v69, s35
    v_lshrrev_b32 v107, 2, v85
    v_add_u32 v85, s35, v85
    v_or_b32 v37, v37, v107
    v_add_u32 v108, 122976, v106
    ds_write_b32 v53, v37 offset:5120
    ds_write_b32 v85, v108 offset:11520
    v_add_u32 v86, v86, v102
    v_add3_u32 v54, v54, v70, s35
    v_lshrrev_b32 v107, 2, v86
    v_add_u32 v86, s35, v86
    v_or_b32 v38, v38, v107
    v_add_u32 v108, 129280, v106
    ds_write_b32 v54, v38 offset:5120
    ds_write_b32 v86, v108 offset:11520
    v_add_u32 v87, v87, v103
    v_add3_u32 v55, v55, v71, s35
    v_lshrrev_b32 v107, 2, v87
    v_add_u32 v87, s35, v87
    v_or_b32 v39, v39, v107
    v_add_u32 v108, 129312, v106
    ds_write_b32 v55, v39 offset:5120
    ds_write_b32 v87, v108 offset:11520
    v_add_u32 v88, v88, v104
    v_add3_u32 v56, v56, v72, s35
    v_lshrrev_b32 v107, 2, v88
    v_add_u32 v88, s35, v88
    v_or_b32 v40, v40, v107
    v_add_u32 v108, 129344, v106
    ds_write_b32 v56, v40 offset:5120
    ds_write_b32 v88, v108 offset:11520
    v_add_u32 v89, v89, v105
    v_add3_u32 v57, v57, v73, s35
    v_lshrrev_b32 v107, 2, v89
    v_add_u32 v89, s35, v89
    v_or_b32 v41, v41, v107
    v_add_u32 v108, 129376, v106
    ds_write_b32 v57, v41 offset:5120
    ds_write_b32 v89, v108 offset:11520
    ds_read_b128 v[112:115], v110 offset:5120
    ds_read_b128 v[116:119], v110 offset:5920
    ds_read_b128 v[12:15], v110 offset:6720
    ds_read_b128 v[16:19], v110 offset:7520
    v_mov_b32 v30, 162816
    v_mov_b32 v31, 1
    s_mov_b64 exec, 1
    ds_add_u32 v30, v31 offset:12
    v_lshl_add_u32 v30, s33, 2, v30
    ds_add_u32 v30, v31 offset:48
    s_mov_b64 exec, s[56:57]
    s_waitcnt lgkmcnt(5)
    buffer_store_dwordx4 v[112:115], v4, s[8:11], 0 offen offset:0 sc1
    s_waitcnt lgkmcnt(4)
    buffer_store_dwordx4 v[116:119], v4, s[8:11], 0 offen offset:800 sc1
    s_waitcnt lgkmcnt(3)
    buffer_store_dwordx4 v[12:15], v4, s[8:11], 0 offen offset:1600 sc1
    s_waitcnt lgkmcnt(2)
    buffer_store_dwordx4 v[16:19], v4, s[8:11], 0 offen offset:2400 sc1
    s_mov_b64 exec, -1
    buffer_store_dwordx4 v[22:25], v10, s[28:31], 0 offen sc1
    v_mov_b32 v30, 162816
    v_mov_b32 v31, 1
    s_mov_b64 exec, 1
    ds_add_u32 v30, v31 offset:56
    s_mov_b64 exec, -1
    s_mov_b32 s39, 1
K_PUB:
    v_mov_b32 v30, 162816
    s_mov_b32 s38, 524288
K_NONCE:
    ds_read_b32 v31, v30 offset:20
    s_waitcnt lgkmcnt(0)
    v_readfirstlane_b32 s37, v31
    s_cmp_ge_u32 s37, 1
    s_cbranch_scc1 K_NONCE_OK
    s_sleep 1
    s_sub_u32 s38, s38, 1
    s_cmp_lg_u32 s38, 0
    s_cbranch_scc1 K_NONCE
K_NONCE_OK:
    s_mov_b32 s61, s37
    s_waitcnt vmcnt(0)
    v_mov_b32 v30, 162816
    v_mov_b32 v31, 1
    s_mov_b64 exec, 1
    ds_add_rtn_u32 v31, v30, v31 offset:0
    s_mov_b64 exec, -1
    s_waitcnt lgkmcnt(0)
    v_readfirstlane_b32 s37, v31
    s_cmp_eq_u32 s37, s39
    s_cbranch_scc0 K_SIG1D
    s_lshl_b32 s37, s2, 4
    s_add_u32 s37, s37, 16384000
    v_mov_b32 v30, 0
    v_mov_b32 v31, s61
    s_mov_b64 exec, 1
    buffer_store_dword v31, v30, s[20:23], s37 offen sc1
    s_mov_b64 exec, -1
K_SIG1D:
    s_cmp_lg_u32 s33, 0
    s_cbranch_scc1 K_W1
    s_setprio 0
    v_and_b32 v30, 63, v250
    v_lshlrev_b32 v30, 4, v30
    s_mov_b32 s38, 524288
    s_mov_b32 s39, 16384000
    s_cmp_ge_u32 s2, 8
    s_cbranch_scc1 K_P1_L
K_P1:
    buffer_load_dword v31, v30, s[20:23], s39 offen offset:0 sc1
    buffer_load_dword v32, v30, s[20:23], s39 offen offset:1024 sc1
    buffer_load_dword v33, v30, s[20:23], s39 offen offset:2048 sc1
    buffer_load_dword v34, v30, s[20:23], s39 offen offset:3072 sc1
    s_waitcnt vmcnt(0)
    v_xor_b32 v31, s61, v31
    v_xor_b32 v32, s61, v32
    v_xor_b32 v33, s61, v33
    v_xor_b32 v34, s61, v34
    v_or3_b32 v31, v31, v32, v33
    v_or_b32 v31, v31, v34
    v_cmp_ne_u32 vcc, 0, v31
    s_cbranch_vccz K_P1_A
    s_sleep 2
    s_sub_u32 s38, s38, 1
    s_cmp_lg_u32 s38, 0
    s_cbranch_scc1 K_P1
K_P1_A:
    s_lshl_b32 s39, s2, 8
    s_add_u32 s39, s39, 16388096
    v_mov_b32 v30, 0
    v_mov_b32 v31, s61
    s_mov_b64 exec, 1
    buffer_store_dword v31, v30, s[20:23], s39 offen sc1
    s_mov_b64 exec, -1
    s_branch K_P1_OK
K_P1_L:
    s_and_b32 s39, s2, 7
    s_lshl_b32 s39, s39, 8
    s_add_u32 s39, s39, 16388096
    v_mov_b32 v30, 0
    s_mov_b64 exec, 1
K_P1_M:
    buffer_load_dword v31, v30, s[20:23], s39 offen sc1
    s_waitcnt vmcnt(0)
    v_cmp_ne_u32 vcc, s61, v31
    s_cbranch_vccz K_P1_N
    s_sleep 4
    s_sub_u32 s38, s38, 1
    s_cmp_lg_u32 s38, 0
    s_cbranch_scc1 K_P1_M
K_P1_N:
    s_mov_b64 exec, -1
K_P1_OK:
    v_mov_b32 v30, 162816
    v_mov_b32 v31, 1
    ds_write_b32 v30, v31 offset:4
    s_branch K_GO1
K_S3B:
    v_bfe_u32 v24, v2, 1, 4
    v_and_b32 v21, 1, v2
    v_lshlrev_b32 v21, 2, v21
    v_and_b32 v26, 1, v24
    v_lshlrev_b32 v26, 4, v26
    v_mov_b32 v27, 0x3f80
    v_lshlrev_b32 v27, v26, v27
    v_lshrrev_b32 v24, 1, v24
    v_sub_u32 v24, v24, v21
    v_lshlrev_b32 v192, 4, v2
    v_mov_b32 v196, 0
    v_mov_b32 v197, 0
    v_mov_b32 v198, 0
    v_mov_b32 v199, 0
    v_cmp_eq_u32 vcc, 0, v24
    s_nop 1
    v_cndmask_b32 v200, 0, v27, vcc
    v_cmp_eq_u32 vcc, 1, v24
    s_nop 1
    v_cndmask_b32 v201, 0, v27, vcc
    v_cmp_eq_u32 vcc, 2, v24
    s_nop 1
    v_cndmask_b32 v202, 0, v27, vcc
    v_cmp_eq_u32 vcc, 3, v24
    s_nop 1
    v_cndmask_b32 v203, 0, v27, vcc
    s_mov_b32 s39, 524288
K_N3:
    global_load_dword v120, v9, s[80:81] sc1
    s_waitcnt vmcnt(0)
    v_readfirstlane_b32 s61, v120
    s_cmp_lg_u32 s61, 0
    s_cbranch_scc1 K_N3OK
    s_sleep 2
    s_sub_u32 s39, s39, 1
    s_cmp_lg_u32 s39, 0
    s_cbranch_scc1 K_N3
K_N3OK:
    v_mov_b32 v30, 162816
    ds_write_b32 v30, v120 offset:20
    s_cmp_ge_u32 s2, 250
    s_cbranch_scc1 K_NOEA3
    s_mul_i32 s39, s2, 51200
    s_add_u32 s8, s66, s39
    s_addc_u32 s9, s67, 0
    s_mov_b32 s10, 51200
    s_mov_b32 s11, 0x20000
    v_lshlrev_b32 v22, 4, v2
    v_mov_b32 v30, 162816
    s_mov_b32 s38, 524288
K_WX3:
    ds_read_b32 v31, v30 offset:40
    s_waitcnt lgkmcnt(0)
    v_readfirstlane_b32 s37, v31
    s_cmp_ge_u32 s37, 4
    s_cbranch_scc1 K_WX3_OK
    s_sleep 1
    s_sub_u32 s38, s38, 1
    s_cmp_lg_u32 s38, 0
    s_cbranch_scc1 K_WX3
K_WX3_OK:
    s_nop 1
    s_mov_b32 m0, 135680
    s_mov_b32 s37, 25600
    buffer_load_dwordx4 v22, s[8:11], s37 offen offset:0 lds
    buffer_load_dwordx4 v22, s[8:11], s37 offen offset:1024 lds
    buffer_load_dwordx4 v22, s[8:11], s37 offen offset:2048 lds
    buffer_load_dwordx4 v22, s[8:11], s37 offen offset:3072 lds
    s_mov_b32 m0, 139776
    s_mov_b32 s37, 29696
    buffer_load_dwordx4 v22, s[8:11], s37 offen offset:0 lds
    buffer_load_dwordx4 v22, s[8:11], s37 offen offset:1024 lds
    buffer_load_dwordx4 v22, s[8:11], s37 offen offset:2048 lds
    buffer_load_dwordx4 v22, s[8:11], s37 offen offset:3072 lds
    s_mov_b32 m0, 143872
    s_mov_b32 s37, 33792
    buffer_load_dwordx4 v22, s[8:11], s37 offen offset:0 lds
    buffer_load_dwordx4 v22, s[8:11], s37 offen offset:1024 lds
    buffer_load_dwordx4 v22, s[8:11], s37 offen offset:2048 lds
    buffer_load_dwordx4 v22, s[8:11], s37 offen offset:3072 lds
    s_mov_b32 m0, 147968
    s_mov_b32 s37, 37888
    buffer_load_dwordx4 v22, s[8:11], s37 offen offset:0 lds
    buffer_load_dwordx4 v22, s[8:11], s37 offen offset:1024 lds
    buffer_load_dwordx4 v22, s[8:11], s37 offen offset:2048 lds
    buffer_load_dwordx4 v22, s[8:11], s37 offen offset:3072 lds
    v_mov_b32 v30, 162816
    s_mov_b32 s38, 524288
K_WX3H:
    ds_read_b32 v31, v30 offset:56
    s_waitcnt lgkmcnt(0)
    v_readfirstlane_b32 s37, v31
    s_cmp_ge_u32 s37, 2
    s_cbranch_scc1 K_WX3H_OK
    s_sleep 1
    s_sub_u32 s38, s38, 1
    s_cmp_lg_u32 s38, 0
    s_cbranch_scc1 K_WX3H
K_WX3H_OK:
    s_nop 1
    s_mov_b32 m0, 152064
    s_mov_b32 s37, 41984
    buffer_load_dwordx4 v22, s[8:11], s37 offen offset:0 lds
    buffer_load_dwordx4 v22, s[8:11], s37 offen offset:1024 lds
    buffer_load_dwordx4 v22, s[8:11], s37 offen offset:2048 lds
    buffer_load_dwordx4 v22, s[8:11], s37 offen offset:3072 lds
    s_mov_b32 m0, 156160
    s_mov_b32 s37, 46080
    buffer_load_dwordx4 v22, s[8:11], s37 offen offset:0 lds
    buffer_load_dwordx4 v22, s[8:11], s37 offen offset:1024 lds
    buffer_load_dwordx4 v22, s[8:11], s37 offen offset:2048 lds
    buffer_load_dwordx4 v22, s[8:11], s37 offen offset:3072 lds
    s_mov_b32 m0, 160256
    s_mov_b32 s37, 50176
    buffer_load_dwordx4 v22, s[8:11], s37 offen offset:0 lds
    s_waitcnt vmcnt(0)
K_NOEA3:
    v_mov_b32 v30, 162816
    v_mov_b32 v31, 1
    s_mov_b64 exec, 1
    ds_add_u32 v30, v31 offset:12
    s_mov_b64 exec, -1
K_W1:
    s_setprio 0
    v_mov_b32 v30, 162816
    s_mov_b32 s38, 524288
K_W1L:
    ds_read_b32 v31, v30 offset:4
    s_waitcnt lgkmcnt(0)
    v_readfirstlane_b32 s37, v31
    s_cmp_ge_u32 s37, 1
    s_cbranch_scc1 K_W1L_OK
    s_sleep 1
    s_sub_u32 s38, s38, 1
    s_cmp_lg_u32 s38, 0
    s_cbranch_scc1 K_W1L
K_W1L_OK:
K_GO1:
    v_lshlrev_b32 v6, 10, v250
    s_lshl_b32 s34, s32, 2
    s_add_u32 s34, s34, 15728640
    s_add_u32 s35, s34, 262144
    v_mov_b32 v8, 0
    s_movk_i32 s37, 244
    v_cmp_gt_u32 vcc, s37, v250
    buffer_load_dword v7, v6, s[20:23], s34 offen sc1
    s_mov_b64 exec, vcc
    buffer_load_dword v8, v6, s[20:23], s35 offen sc1
    s_mov_b64 exec, -1
    s_mov_b32 s37, 0xffff
    s_waitcnt vmcnt(0)
    v_lshlrev_b32 v251, 16, v8
    v_bfi_b32 v251, s37, v7, v251
    v_lshrrev_b32 v252, 16, v7
    v_bfi_b32 v252, s37, v252, v8
K2_ROUND:
    s_cmp_ge_u32 s33, 4
    s_cbranch_scc1 K2_JOIN
    v_subrev_u32 v103, s40, v250
    v_cmp_gt_u32 vcc, s41, v103
    v_sub_u32_sdwa v96, v252, v251 dst_sel:DWORD dst_unused:UNUSED_PAD src0_sel:WORD_0 src1_sel:WORD_0
    v_sub_u32_sdwa v97, v252, v251 dst_sel:DWORD dst_unused:UNUSED_PAD src0_sel:WORD_1 src1_sel:WORD_1
    v_mul_u32_u24 v104, 3200, v250
    v_cndmask_b32 v96, 0, v96, vcc
    v_cndmask_b32 v97, 0, v97, vcc
    v_add_u32_sdwa v101, v104, v251 dst_sel:DWORD dst_unused:UNUSED_PAD src0_sel:DWORD src1_sel:WORD_0
    v_add_u32_sdwa v102, v104, v251 dst_sel:DWORD dst_unused:UNUSED_PAD src0_sel:DWORD src1_sel:WORD_1
    s_mov_b32 s37, 13631488
    s_mov_b32 s38, 14450688
    v_cmp_lt_u32 vcc, 0, v96
    s_and_saveexec_b64 s[34:35], vcc
    s_cbranch_execz K2_RL00
    buffer_load_dwordx4 v[0:3], v101, s[20:23], s37 offen offset:0 sc1
K2_RL00:
    s_mov_b64 exec, s[34:35]
    v_cmp_lt_u32 vcc, 0, v97
    s_and_saveexec_b64 s[34:35], vcc
    s_cbranch_execz K2_RL01
    buffer_load_dwordx4 v[16:19], v102, s[20:23], s38 offen offset:0 sc1
K2_RL01:
    s_mov_b64 exec, s[34:35]
    v_cmp_lt_u32 vcc, 16, v96
    s_and_saveexec_b64 s[34:35], vcc
    s_cbranch_execz K2_RL10
    buffer_load_dwordx4 v[4:7], v101, s[20:23], s37 offen offset:16 sc1
K2_RL10:
    s_mov_b64 exec, s[34:35]
    v_cmp_lt_u32 vcc, 16, v97
    s_and_saveexec_b64 s[34:35], vcc
    s_cbranch_execz K2_RL11
    buffer_load_dwordx4 v[20:23], v102, s[20:23], s38 offen offset:16 sc1
K2_RL11:
    s_mov_b64 exec, s[34:35]
    v_cmp_lt_u32 vcc, 32, v96
    s_and_saveexec_b64 s[34:35], vcc
    s_cbranch_execz K2_RL20
    buffer_load_dwordx4 v[8:11], v101, s[20:23], s37 offen offset:32 sc1
K2_RL20:
    s_mov_b64 exec, s[34:35]
    v_cmp_lt_u32 vcc, 32, v97
    s_and_saveexec_b64 s[34:35], vcc
    s_cbranch_execz K2_RL21
    buffer_load_dwordx4 v[24:27], v102, s[20:23], s38 offen offset:32 sc1
K2_RL21:
    s_mov_b64 exec, s[34:35]
    v_cmp_lt_u32 vcc, 48, v96
    s_and_saveexec_b64 s[34:35], vcc
    s_cbranch_execz K2_RL30
    buffer_load_dwordx4 v[12:15], v101, s[20:23], s37 offen offset:48 sc1
K2_RL30:
    s_mov_b64 exec, s[34:35]
    v_cmp_lt_u32 vcc, 48, v97
    s_and_saveexec_b64 s[34:35], vcc
    s_cbranch_execz K2_RL31
    buffer_load_dwordx4 v[28:31], v102, s[20:23], s38 offen offset:48 sc1
K2_RL31:
    s_mov_b64 exec, s[34:35]
    s_cmp_eq_u32 s58, 0
    s_cbranch_scc1 K2_TOK
    s_cmp_lg_u32 s33, 3
    s_cbranch_scc1 K2_TW
    v_mov_b32 v103, 162816
    s_mov_b32 s38, 524288
K_WD3:
    ds_read_b32 v104, v103 offset:28
    s_waitcnt lgkmcnt(0)
    v_readfirstlane_b32 s37, v104
    s_cmp_ge_u32 s37, 4
    s_cbranch_scc1 K_WD3_OK
    s_sleep 1
    s_sub_u32 s38, s38, 1
    s_cmp_lg_u32 s38, 0
    s_cbranch_scc1 K_WD3
K_WD3_OK:
    ds_write_b128 v192, v[196:199] offset:0
    ds_write_b128 v192, v[200:203] offset:2048
    s_mov_b64 exec, 0xffff
    ds_write_b128 v192, v[196:199] offset:3072
    s_mov_b64 exec, -1
    v_mov_b32 v103, 162816
    v_mov_b32 v104, 1
    s_mov_b64 exec, 1
    ds_add_u32 v103, v104 offset:44
    s_mov_b64 exec, -1
K2_TW:
    v_mov_b32 v103, 162816
    s_mov_b32 s38, 524288
K_WT:
    ds_read_b32 v104, v103 offset:44
    s_waitcnt lgkmcnt(0)
    v_readfirstlane_b32 s37, v104
    s_cmp_ge_u32 s37, 1
    s_cbranch_scc1 K_WT_OK
    s_sleep 1
    s_sub_u32 s38, s38, 1
    s_cmp_lg_u32 s38, 0
    s_cbranch_scc1 K_WT
K_WT_OK:
K2_TOK:
    v_mov_b32 v98, 4
    v_mul_u32_u24 v99, 25600, v250
    s_movk_i32 s39, 2
    v_add_u32 v100, 6553600, v99
    s_waitcnt vmcnt(0)
    v_cmpx_lt_u32 vcc, 0, v96
    v_lshlrev_b32_sdwa v64, s39, v0 dst_sel:DWORD dst_unused:UNUSED_PAD src0_sel:DWORD src1_sel:BYTE_3
    ds_add_rtn_u32 v32, v64, v98 offset:0
    v_cmpx_lt_u32 vcc, 4, v96
    v_lshlrev_b32_sdwa v65, s39, v1 dst_sel:DWORD dst_unused:UNUSED_PAD src0_sel:DWORD src1_sel:BYTE_3
    ds_add_rtn_u32 v33, v65, v98 offset:0
    v_cmpx_lt_u32 vcc, 8, v96
    v_lshlrev_b32_sdwa v66, s39, v2 dst_sel:DWORD dst_unused:UNUSED_PAD src0_sel:DWORD src1_sel:BYTE_3
    ds_add_rtn_u32 v34, v66, v98 offset:0
    v_cmpx_lt_u32 vcc, 12, v96
    v_lshlrev_b32_sdwa v67, s39, v3 dst_sel:DWORD dst_unused:UNUSED_PAD src0_sel:DWORD src1_sel:BYTE_3
    ds_add_rtn_u32 v35, v67, v98 offset:0
    v_cmpx_lt_u32 vcc, 16, v96
    v_lshlrev_b32_sdwa v68, s39, v4 dst_sel:DWORD dst_unused:UNUSED_PAD src0_sel:DWORD src1_sel:BYTE_3
    s_cbranch_execz K2_CDONE0
    ds_add_rtn_u32 v36, v68, v98 offset:0
    v_cmpx_lt_u32 vcc, 20, v96
    v_lshlrev_b32_sdwa v69, s39, v5 dst_sel:DWORD dst_unused:UNUSED_PAD src0_sel:DWORD src1_sel:BYTE_3
    s_cbranch_execz K2_CDONE0
    ds_add_rtn_u32 v37, v69, v98 offset:0
    v_cmpx_lt_u32 vcc, 24, v96
    v_lshlrev_b32_sdwa v70, s39, v6 dst_sel:DWORD dst_unused:UNUSED_PAD src0_sel:DWORD src1_sel:BYTE_3
    s_cbranch_execz K2_CDONE0
    ds_add_rtn_u32 v38, v70, v98 offset:0
    v_cmpx_lt_u32 vcc, 28, v96
    v_lshlrev_b32_sdwa v71, s39, v7 dst_sel:DWORD dst_unused:UNUSED_PAD src0_sel:DWORD src1_sel:BYTE_3
    s_cbranch_execz K2_CDONE0
    ds_add_rtn_u32 v39, v71, v98 offset:0
    v_cmpx_lt_u32 vcc, 32, v96
    v_lshlrev_b32_sdwa v72, s39, v8 dst_sel:DWORD dst_unused:UNUSED_PAD src0_sel:DWORD src1_sel:BYTE_3
    s_cbranch_execz K2_CDONE0
    ds_add_rtn_u32 v40, v72, v98 offset:0
    v_cmpx_lt_u32 vcc, 36, v96
    v_lshlrev_b32_sdwa v73, s39, v9 dst_sel:DWORD dst_unused:UNUSED_PAD src0_sel:DWORD src1_sel:BYTE_3
    s_cbranch_execz K2_CDONE0
    ds_add_rtn_u32 v41, v73, v98 offset:0
    v_cmpx_lt_u32 vcc, 40, v96
    v_lshlrev_b32_sdwa v74, s39, v10 dst_sel:DWORD dst_unused:UNUSED_PAD src0_sel:DWORD src1_sel:BYTE_3
    s_cbranch_execz K2_CDONE0
    ds_add_rtn_u32 v42, v74, v98 offset:0
    v_cmpx_lt_u32 vcc, 44, v96
    v_lshlrev_b32_sdwa v75, s39, v11 dst_sel:DWORD dst_unused:UNUSED_PAD src0_sel:DWORD src1_sel:BYTE_3
    s_cbranch_execz K2_CDONE0
    ds_add_rtn_u32 v43, v75, v98 offset:0
    v_cmpx_lt_u32 vcc, 48, v96
    v_lshlrev_b32_sdwa v76, s39, v12 dst_sel:DWORD dst_unused:UNUSED_PAD src0_sel:DWORD src1_sel:BYTE_3
    s_cbranch_execz K2_CDONE0
    ds_add_rtn_u32 v44, v76, v98 offset:0
    v_cmpx_lt_u32 vcc, 52, v96
    v_lshlrev_b32_sdwa v77, s39, v13 dst_sel:DWORD dst_unused:UNUSED_PAD src0_sel:DWORD src1_sel:BYTE_3
    s_cbranch_execz K2_CDONE0
    ds_add_rtn_u32 v45, v77, v98 offset:0
    v_cmpx_lt_u32 vcc, 56, v96
    v_lshlrev_b32_sdwa v78, s39, v14 dst_sel:DWORD dst_unused:UNUSED_PAD src0_sel:DWORD src1_sel:BYTE_3
    s_cbranch_execz K2_CDONE0
    ds_add_rtn_u32 v46, v78, v98 offset:0
    v_cmpx_lt_u32 vcc, 60, v96
    v_lshlrev_b32_sdwa v79, s39, v15 dst_sel:DWORD dst_unused:UNUSED_PAD src0_sel:DWORD src1_sel:BYTE_3
    s_cbranch_execz K2_CDONE0
    ds_add_rtn_u32 v47, v79, v98 offset:0
    v_cmp_lt_u32 vcc, 64, v96
    s_and_b64 exec, exec, vcc
    s_cbranch_scc0 K2_CDONE0
    v_mov_b32 v103, 0
    ds_write_b32 v103, v98 offset:3072
K2_CDONE0:
    s_mov_b64 exec, -1
    v_cmpx_lt_u32 vcc, 0, v97
    v_lshlrev_b32_sdwa v80, s39, v16 dst_sel:DWORD dst_unused:UNUSED_PAD src0_sel:DWORD src1_sel:BYTE_3
    ds_add_rtn_u32 v48, v80, v98 offset:0
    v_cmpx_lt_u32 vcc, 4, v97
    v_lshlrev_b32_sdwa v81, s39, v17 dst_sel:DWORD dst_unused:UNUSED_PAD src0_sel:DWORD src1_sel:BYTE_3
    ds_add_rtn_u32 v49, v81, v98 offset:0
    v_cmpx_lt_u32 vcc, 8, v97
    v_lshlrev_b32_sdwa v82, s39, v18 dst_sel:DWORD dst_unused:UNUSED_PAD src0_sel:DWORD src1_sel:BYTE_3
    ds_add_rtn_u32 v50, v82, v98 offset:0
    v_cmpx_lt_u32 vcc, 12, v97
    v_lshlrev_b32_sdwa v83, s39, v19 dst_sel:DWORD dst_unused:UNUSED_PAD src0_sel:DWORD src1_sel:BYTE_3
    ds_add_rtn_u32 v51, v83, v98 offset:0
    v_cmpx_lt_u32 vcc, 16, v97
    v_lshlrev_b32_sdwa v84, s39, v20 dst_sel:DWORD dst_unused:UNUSED_PAD src0_sel:DWORD src1_sel:BYTE_3
    s_cbranch_execz K2_CDONE1
    ds_add_rtn_u32 v52, v84, v98 offset:0
    v_cmpx_lt_u32 vcc, 20, v97
    v_lshlrev_b32_sdwa v85, s39, v21 dst_sel:DWORD dst_unused:UNUSED_PAD src0_sel:DWORD src1_sel:BYTE_3
    s_cbranch_execz K2_CDONE1
    ds_add_rtn_u32 v53, v85, v98 offset:0
    v_cmpx_lt_u32 vcc, 24, v97
    v_lshlrev_b32_sdwa v86, s39, v22 dst_sel:DWORD dst_unused:UNUSED_PAD src0_sel:DWORD src1_sel:BYTE_3
    s_cbranch_execz K2_CDONE1
    ds_add_rtn_u32 v54, v86, v98 offset:0
    v_cmpx_lt_u32 vcc, 28, v97
    v_lshlrev_b32_sdwa v87, s39, v23 dst_sel:DWORD dst_unused:UNUSED_PAD src0_sel:DWORD src1_sel:BYTE_3
    s_cbranch_execz K2_CDONE1
    ds_add_rtn_u32 v55, v87, v98 offset:0
    v_cmpx_lt_u32 vcc, 32, v97
    v_lshlrev_b32_sdwa v88, s39, v24 dst_sel:DWORD dst_unused:UNUSED_PAD src0_sel:DWORD src1_sel:BYTE_3
    s_cbranch_execz K2_CDONE1
    ds_add_rtn_u32 v56, v88, v98 offset:0
    v_cmpx_lt_u32 vcc, 36, v97
    v_lshlrev_b32_sdwa v89, s39, v25 dst_sel:DWORD dst_unused:UNUSED_PAD src0_sel:DWORD src1_sel:BYTE_3
    s_cbranch_execz K2_CDONE1
    ds_add_rtn_u32 v57, v89, v98 offset:0
    v_cmpx_lt_u32 vcc, 40, v97
    v_lshlrev_b32_sdwa v90, s39, v26 dst_sel:DWORD dst_unused:UNUSED_PAD src0_sel:DWORD src1_sel:BYTE_3
    s_cbranch_execz K2_CDONE1
    ds_add_rtn_u32 v58, v90, v98 offset:0
    v_cmpx_lt_u32 vcc, 44, v97
    v_lshlrev_b32_sdwa v91, s39, v27 dst_sel:DWORD dst_unused:UNUSED_PAD src0_sel:DWORD src1_sel:BYTE_3
    s_cbranch_execz K2_CDONE1
    ds_add_rtn_u32 v59, v91, v98 offset:0
    v_cmpx_lt_u32 vcc, 48, v97
    v_lshlrev_b32_sdwa v92, s39, v28 dst_sel:DWORD dst_unused:UNUSED_PAD src0_sel:DWORD src1_sel:BYTE_3
    s_cbranch_execz K2_CDONE1
    ds_add_rtn_u32 v60, v92, v98 offset:0
    v_cmpx_lt_u32 vcc, 52, v97
    v_lshlrev_b32_sdwa v93, s39, v29 dst_sel:DWORD dst_unused:UNUSED_PAD src0_sel:DWORD src1_sel:BYTE_3
    s_cbranch_execz K2_CDONE1
    ds_add_rtn_u32 v61, v93, v98 offset:0
    v_cmpx_lt_u32 vcc, 56, v97
    v_lshlrev_b32_sdwa v94, s39, v30 dst_sel:DWORD dst_unused:UNUSED_PAD src0_sel:DWORD src1_sel:BYTE_3
    s_cbranch_execz K2_CDONE1
    ds_add_rtn_u32 v62, v94, v98 offset:0
    v_cmpx_lt_u32 vcc, 60, v97
    v_lshlrev_b32_sdwa v95, s39, v31 dst_sel:DWORD dst_unused:UNUSED_PAD src0_sel:DWORD src1_sel:BYTE_3
    s_cbranch_execz K2_CDONE1
    ds_add_rtn_u32 v63, v95, v98 offset:0
    v_cmp_lt_u32 vcc, 64, v97
    s_and_b64 exec, exec, vcc
    s_cbranch_scc0 K2_CDONE1
    v_mov_b32 v103, 0
    ds_write_b32 v103, v98 offset:3072
K2_CDONE1:
    s_mov_b64 exec, -1
    v_mov_b32 v103, 162816
    v_mov_b32 v104, 1
    v_and_b32 v192, 63, v250
    v_lshrrev_b32 v195, 3, v192
    v_lshlrev_b32 v194, 4, v192
    v_mul_u32_u24 v204, 1408, v195
    v_and_b32 v195, 7, v192
    v_add_u32 v200, -1, v195
    v_add_u32 v201, -2, v195
    v_add_u32 v202, -4, v195
    v_ashrrev_i32 v200, 31, v200
    v_ashrrev_i32 v201, 31, v201
    v_ashrrev_i32 v202, 31, v202
    s_waitcnt lgkmcnt(0)
    s_mov_b64 exec, 1
    ds_add_u32 v103, v104 offset:8
    s_mov_b64 exec, -1
    v_mov_b32 v103, 162816
    s_mov_b32 s38, 524288
K2_SS:
    ds_read_b32 v104, v103 offset:8
    s_waitcnt lgkmcnt(0)
    v_readfirstlane_b32 s37, v104
    s_cmp_ge_u32 s37, s62
    s_cbranch_scc1 K2_SS_OK
    s_sleep 1
    s_sub_u32 s38, s38, 1
    s_cmp_lg_u32 s38, 0
    s_cbranch_scc1 K2_SS
K2_SS_OK:
    s_add_u32 s62, s62, 4
    ds_read_b128 v[196:199], v194 offset:0
    v_max_u32 v103, v96, v97
    s_waitcnt lgkmcnt(0)
    v_add_u32 v197, v197, v196
    v_add_u32 v198, v198, v197
    v_add_u32 v199, v199, v198
    v_mov_b32 v212, v199
    s_nop 1
    v_mov_b32_dpp v203, v212 row_shr:1 row_mask:0xf bank_mask:0xf
    v_bfi_b32 v203, v200, 0, v203
    v_add_u32 v212, v212, v203
    s_nop 1
    v_mov_b32_dpp v203, v212 row_shr:2 row_mask:0xf bank_mask:0xf
    v_bfi_b32 v203, v201, 0, v203
    v_add_u32 v212, v212, v203
    s_nop 1
    v_mov_b32_dpp v203, v212 row_shr:4 row_mask:0xf bank_mask:0xf
    v_bfi_b32 v203, v202, 0, v203
    v_add_u32 v212, v212, v203
    s_nop 1
    v_sub_u32 v204, v204, v199
    s_movk_i32 s37, 1280
    v_add_u32 v204, v204, v212
    v_cmp_lt_u32 vcc, s37, v212
    v_add_u32 v205, v204, v196
    v_add_u32 v206, v204, v197
    v_add_u32 v207, v204, v198
    ds_write_b128 v194, v[204:207] offset:1024
    v_lshrrev_b32 v195, 1, v192
    v_and_b32 v195, 28, v195
    s_mov_b32 exec_lo, 0x80808080
    s_mov_b32 exec_hi, 0x80808080
    ds_write_b32 v195, v212 offset:3104
    s_mov_b64 exec, -1
    s_cbranch_vccnz K2_JOIN
    v_cmp_lt_u32 vcc, 40, v103
    s_waitcnt lgkmcnt(0)
    ds_read_b32 v64, v64 offset:1024
    ds_read_b32 v65, v65 offset:1024
    ds_read_b32 v66, v66 offset:1024
    ds_read_b32 v67, v67 offset:1024
    ds_read_b32 v68, v68 offset:1024
    ds_read_b32 v69, v69 offset:1024
    ds_read_b32 v70, v70 offset:1024
    ds_read_b32 v71, v71 offset:1024
    ds_read_b32 v72, v72 offset:1024
    ds_read_b32 v73, v73 offset:1024
    ds_read_b32 v80, v80 offset:1024
    ds_read_b32 v81, v81 offset:1024
    ds_read_b32 v82, v82 offset:1024
    ds_read_b32 v83, v83 offset:1024
    ds_read_b32 v84, v84 offset:1024
    ds_read_b32 v85, v85 offset:1024
    ds_read_b32 v86, v86 offset:1024
    ds_read_b32 v87, v87 offset:1024
    ds_read_b32 v88, v88 offset:1024
    ds_read_b32 v89, v89 offset:1024
    s_cbranch_vccz K2_BDONE
    ds_read_b32 v74, v74 offset:1024
    ds_read_b32 v75, v75 offset:1024
    ds_read_b32 v76, v76 offset:1024
    ds_read_b32 v77, v77 offset:1024
    ds_read_b32 v78, v78 offset:1024
    ds_read_b32 v79, v79 offset:1024
    ds_read_b32 v90, v90 offset:1024
    ds_read_b32 v91, v91 offset:1024
    ds_read_b32 v92, v92 offset:1024
    ds_read_b32 v93, v93 offset:1024
    ds_read_b32 v94, v94 offset:1024
    ds_read_b32 v95, v95 offset:1024
K2_BDONE:
    s_waitcnt lgkmcnt(0)
    v_cmpx_lt_u32 vcc, 0, v96
    v_add_u32 v64, v64, v32
    v_and_b32 v104, 0x3ff, v0
    v_lshrrev_b32 v103, 5, v0
    v_lshl_add_u32 v104, v104, 5, v99
    ds_write2st64_b32 v64, v103, v104 offset0:13 offset1:57
    v_cmpx_lt_u32 vcc, 4, v96
    v_add_u32 v65, v65, v33
    v_and_b32 v104, 0x3ff, v1
    v_lshrrev_b32 v103, 5, v1
    v_lshl_add_u32 v104, v104, 5, v99
    ds_write2st64_b32 v65, v103, v104 offset0:13 offset1:57
    v_cmpx_lt_u32 vcc, 8, v96
    v_add_u32 v66, v66, v34
    v_and_b32 v104, 0x3ff, v2
    v_lshrrev_b32 v103, 5, v2
    v_lshl_add_u32 v104, v104, 5, v99
    ds_write2st64_b32 v66, v103, v104 offset0:13 offset1:57
    v_cmpx_lt_u32 vcc, 12, v96
    v_add_u32 v67, v67, v35
    v_and_b32 v104, 0x3ff, v3
    v_lshrrev_b32 v103, 5, v3
    v_lshl_add_u32 v104, v104, 5, v99
    ds_write2st64_b32 v67, v103, v104 offset0:13 offset1:57
    v_cmpx_lt_u32 vcc, 16, v96
    v_add_u32 v68, v68, v36
    s_cbranch_execz K2_SDONE0
    v_and_b32 v104, 0x3ff, v4
    v_lshrrev_b32 v103, 5, v4
    v_lshl_add_u32 v104, v104, 5, v99
    ds_write2st64_b32 v68, v103, v104 offset0:13 offset1:57
    v_cmpx_lt_u32 vcc, 20, v96
    v_add_u32 v69, v69, v37
    s_cbranch_execz K2_SDONE0
    v_and_b32 v104, 0x3ff, v5
    v_lshrrev_b32 v103, 5, v5
    v_lshl_add_u32 v104, v104, 5, v99
    ds_write2st64_b32 v69, v103, v104 offset0:13 offset1:57
    v_cmpx_lt_u32 vcc, 24, v96
    v_add_u32 v70, v70, v38
    s_cbranch_execz K2_SDONE0
    v_and_b32 v104, 0x3ff, v6
    v_lshrrev_b32 v103, 5, v6
    v_lshl_add_u32 v104, v104, 5, v99
    ds_write2st64_b32 v70, v103, v104 offset0:13 offset1:57
    v_cmpx_lt_u32 vcc, 28, v96
    v_add_u32 v71, v71, v39
    s_cbranch_execz K2_SDONE0
    v_and_b32 v104, 0x3ff, v7
    v_lshrrev_b32 v103, 5, v7
    v_lshl_add_u32 v104, v104, 5, v99
    ds_write2st64_b32 v71, v103, v104 offset0:13 offset1:57
    v_cmpx_lt_u32 vcc, 32, v96
    v_add_u32 v72, v72, v40
    s_cbranch_execz K2_SDONE0
    v_and_b32 v104, 0x3ff, v8
    v_lshrrev_b32 v103, 5, v8
    v_lshl_add_u32 v104, v104, 5, v99
    ds_write2st64_b32 v72, v103, v104 offset0:13 offset1:57
    v_cmpx_lt_u32 vcc, 36, v96
    v_add_u32 v73, v73, v41
    s_cbranch_execz K2_SDONE0
    v_and_b32 v104, 0x3ff, v9
    v_lshrrev_b32 v103, 5, v9
    v_lshl_add_u32 v104, v104, 5, v99
    ds_write2st64_b32 v73, v103, v104 offset0:13 offset1:57
    v_cmpx_lt_u32 vcc, 40, v96
    v_add_u32 v74, v74, v42
    s_cbranch_execz K2_SDONE0
    v_and_b32 v104, 0x3ff, v10
    v_lshrrev_b32 v103, 5, v10
    v_lshl_add_u32 v104, v104, 5, v99
    ds_write2st64_b32 v74, v103, v104 offset0:13 offset1:57
    v_cmpx_lt_u32 vcc, 44, v96
    v_add_u32 v75, v75, v43
    s_cbranch_execz K2_SDONE0
    v_and_b32 v104, 0x3ff, v11
    v_lshrrev_b32 v103, 5, v11
    v_lshl_add_u32 v104, v104, 5, v99
    ds_write2st64_b32 v75, v103, v104 offset0:13 offset1:57
    v_cmpx_lt_u32 vcc, 48, v96
    v_add_u32 v76, v76, v44
    s_cbranch_execz K2_SDONE0
    v_and_b32 v104, 0x3ff, v12
    v_lshrrev_b32 v103, 5, v12
    v_lshl_add_u32 v104, v104, 5, v99
    ds_write2st64_b32 v76, v103, v104 offset0:13 offset1:57
    v_cmpx_lt_u32 vcc, 52, v96
    v_add_u32 v77, v77, v45
    s_cbranch_execz K2_SDONE0
    v_and_b32 v104, 0x3ff, v13
    v_lshrrev_b32 v103, 5, v13
    v_lshl_add_u32 v104, v104, 5, v99
    ds_write2st64_b32 v77, v103, v104 offset0:13 offset1:57
    v_cmpx_lt_u32 vcc, 56, v96
    v_add_u32 v78, v78, v46
    s_cbranch_execz K2_SDONE0
    v_and_b32 v104, 0x3ff, v14
    v_lshrrev_b32 v103, 5, v14
    v_lshl_add_u32 v104, v104, 5, v99
    ds_write2st64_b32 v78, v103, v104 offset0:13 offset1:57
    v_cmpx_lt_u32 vcc, 60, v96
    v_add_u32 v79, v79, v47
    s_cbranch_execz K2_SDONE0
    v_and_b32 v104, 0x3ff, v15
    v_lshrrev_b32 v103, 5, v15
    v_lshl_add_u32 v104, v104, 5, v99
    ds_write2st64_b32 v79, v103, v104 offset0:13 offset1:57
K2_SDONE0:
    s_mov_b64 exec, -1
    v_cmpx_lt_u32 vcc, 0, v97
    v_add_u32 v80, v80, v48
    v_and_b32 v104, 0x3ff, v16
    v_lshrrev_b32 v103, 5, v16
    v_lshl_add_u32 v104, v104, 5, v100
    ds_write2st64_b32 v80, v103, v104 offset0:13 offset1:57
    v_cmpx_lt_u32 vcc, 4, v97
    v_add_u32 v81, v81, v49
    v_and_b32 v104, 0x3ff, v17
    v_lshrrev_b32 v103, 5, v17
    v_lshl_add_u32 v104, v104, 5, v100
    ds_write2st64_b32 v81, v103, v104 offset0:13 offset1:57
    v_cmpx_lt_u32 vcc, 8, v97
    v_add_u32 v82, v82, v50
    v_and_b32 v104, 0x3ff, v18
    v_lshrrev_b32 v103, 5, v18
    v_lshl_add_u32 v104, v104, 5, v100
    ds_write2st64_b32 v82, v103, v104 offset0:13 offset1:57
    v_cmpx_lt_u32 vcc, 12, v97
    v_add_u32 v83, v83, v51
    v_and_b32 v104, 0x3ff, v19
    v_lshrrev_b32 v103, 5, v19
    v_lshl_add_u32 v104, v104, 5, v100
    ds_write2st64_b32 v83, v103, v104 offset0:13 offset1:57
    v_cmpx_lt_u32 vcc, 16, v97
    v_add_u32 v84, v84, v52
    s_cbranch_execz K2_SDONE1
    v_and_b32 v104, 0x3ff, v20
    v_lshrrev_b32 v103, 5, v20
    v_lshl_add_u32 v104, v104, 5, v100
    ds_write2st64_b32 v84, v103, v104 offset0:13 offset1:57
    v_cmpx_lt_u32 vcc, 20, v97
    v_add_u32 v85, v85, v53
    s_cbranch_execz K2_SDONE1
    v_and_b32 v104, 0x3ff, v21
    v_lshrrev_b32 v103, 5, v21
    v_lshl_add_u32 v104, v104, 5, v100
    ds_write2st64_b32 v85, v103, v104 offset0:13 offset1:57
    v_cmpx_lt_u32 vcc, 24, v97
    v_add_u32 v86, v86, v54
    s_cbranch_execz K2_SDONE1
    v_and_b32 v104, 0x3ff, v22
    v_lshrrev_b32 v103, 5, v22
    v_lshl_add_u32 v104, v104, 5, v100
    ds_write2st64_b32 v86, v103, v104 offset0:13 offset1:57
    v_cmpx_lt_u32 vcc, 28, v97
    v_add_u32 v87, v87, v55
    s_cbranch_execz K2_SDONE1
    v_and_b32 v104, 0x3ff, v23
    v_lshrrev_b32 v103, 5, v23
    v_lshl_add_u32 v104, v104, 5, v100
    ds_write2st64_b32 v87, v103, v104 offset0:13 offset1:57
    v_cmpx_lt_u32 vcc, 32, v97
    v_add_u32 v88, v88, v56
    s_cbranch_execz K2_SDONE1
    v_and_b32 v104, 0x3ff, v24
    v_lshrrev_b32 v103, 5, v24
    v_lshl_add_u32 v104, v104, 5, v100
    ds_write2st64_b32 v88, v103, v104 offset0:13 offset1:57
    v_cmpx_lt_u32 vcc, 36, v97
    v_add_u32 v89, v89, v57
    s_cbranch_execz K2_SDONE1
    v_and_b32 v104, 0x3ff, v25
    v_lshrrev_b32 v103, 5, v25
    v_lshl_add_u32 v104, v104, 5, v100
    ds_write2st64_b32 v89, v103, v104 offset0:13 offset1:57
    v_cmpx_lt_u32 vcc, 40, v97
    v_add_u32 v90, v90, v58
    s_cbranch_execz K2_SDONE1
    v_and_b32 v104, 0x3ff, v26
    v_lshrrev_b32 v103, 5, v26
    v_lshl_add_u32 v104, v104, 5, v100
    ds_write2st64_b32 v90, v103, v104 offset0:13 offset1:57
    v_cmpx_lt_u32 vcc, 44, v97
    v_add_u32 v91, v91, v59
    s_cbranch_execz K2_SDONE1
    v_and_b32 v104, 0x3ff, v27
    v_lshrrev_b32 v103, 5, v27
    v_lshl_add_u32 v104, v104, 5, v100
    ds_write2st64_b32 v91, v103, v104 offset0:13 offset1:57
    v_cmpx_lt_u32 vcc, 48, v97
    v_add_u32 v92, v92, v60
    s_cbranch_execz K2_SDONE1
    v_and_b32 v104, 0x3ff, v28
    v_lshrrev_b32 v103, 5, v28
    v_lshl_add_u32 v104, v104, 5, v100
    ds_write2st64_b32 v92, v103, v104 offset0:13 offset1:57
    v_cmpx_lt_u32 vcc, 52, v97
    v_add_u32 v93, v93, v61
    s_cbranch_execz K2_SDONE1
    v_and_b32 v104, 0x3ff, v29
    v_lshrrev_b32 v103, 5, v29
    v_lshl_add_u32 v104, v104, 5, v100
    ds_write2st64_b32 v93, v103, v104 offset0:13 offset1:57
    v_cmpx_lt_u32 vcc, 56, v97
    v_add_u32 v94, v94, v62
    s_cbranch_execz K2_SDONE1
    v_and_b32 v104, 0x3ff, v30
    v_lshrrev_b32 v103, 5, v30
    v_lshl_add_u32 v104, v104, 5, v100
    ds_write2st64_b32 v94, v103, v104 offset0:13 offset1:57
    v_cmpx_lt_u32 vcc, 60, v97
    v_add_u32 v95, v95, v63
    s_cbranch_execz K2_SDONE1
    v_and_b32 v104, 0x3ff, v31
    v_lshrrev_b32 v103, 5, v31
    v_lshl_add_u32 v104, v104, 5, v100
    ds_write2st64_b32 v95, v103, v104 offset0:13 offset1:57
K2_SDONE1:
    s_mov_b64 exec, -1
    v_min_u32 v103, 64, v96
    v_min_u32 v104, 64, v97
    v_lshl_add_u32 v103, v104, 16, v103
    v_add_u32 v251, v251, v103
    s_branch K2_JOIN
K_PREP:
    s_setprio 3
    s_sub_u32 s34, s2, 250
    s_mul_i32 s34, s34, 3
    s_add_u32 s34, s34, s33
    v_lshrrev_b32 v3, 4, v2
    v_and_b32 v4, 15, v2
    v_lshlrev_b32 v5, 11, v3
    v_lshl_add_u32 v5, v4, 3, v5
    v_lshlrev_b32 v6, 4, v2
    v_lshlrev_b32 v7, 10, v3
    v_lshl_add_u32 v7, v4, 3, v7
    v_lshlrev_b32 v8, 5, v4
    v_lshl_add_u32 v8, v3, 3, v8
    s_mov_b32 s24, s76
    s_mov_b32 s25, s77
    s_mov_b32 s26, 69632
    s_mov_b32 s27, 0x20000
    s_mov_b32 s4, s72
    s_mov_b32 s5, s73
    s_mov_b32 s6, 32768
    s_mov_b32 s7, 0x20000
    s_mov_b32 s10, 32768
    s_mov_b32 s11, 0x20000
    s_add_u32 s35, s34, 0
    s_lshl_b32 s44, s35, 10
    s_add_u32 s44, s44, 16252928
    s_cmp_ge_u32 s35, 32
    s_cselect_b32 s8, s4, s24
    s_cselect_b32 s9, s5, s25
    s_and_b32 s37, s35, 3
    s_lshl_b32 s37, s37, 13
    s_bfe_u32 s38, s35, 0x10004
    s_lshl_b32 s38, s38, 7
    s_bfe_u32 s39, s35, 0x20002
    s_lshl_b32 s39, s39, 1
    s_add_u32 s37, s37, s38
    s_add_u32 s37, s37, s39
    buffer_load_ushort v16, v5, s[8:11], s37 offen offset:0
    buffer_load_ushort v17, v5, s[8:11], s37 offen offset:256
    buffer_load_ushort v18, v5, s[8:11], s37 offen offset:512
    buffer_load_ushort v19, v5, s[8:11], s37 offen offset:768
    buffer_load_ushort v20, v5, s[8:11], s37 offen offset:1024
    buffer_load_ushort v21, v5, s[8:11], s37 offen offset:1280
    buffer_load_ushort v22, v5, s[8:11], s37 offen offset:1536
    buffer_load_ushort v23, v5, s[8:11], s37 offen offset:1792
    s_add_u32 s35, s34, 18
    s_lshl_b32 s45, s35, 10
    s_add_u32 s45, s45, 16252928
    s_cmp_ge_u32 s35, 32
    s_cselect_b32 s8, s4, s24
    s_cselect_b32 s9, s5, s25
    s_and_b32 s37, s35, 3
    s_lshl_b32 s37, s37, 13
    s_bfe_u32 s38, s35, 0x10004
    s_lshl_b32 s38, s38, 7
    s_bfe_u32 s39, s35, 0x20002
    s_lshl_b32 s39, s39, 1
    s_add_u32 s37, s37, s38
    s_add_u32 s37, s37, s39
    buffer_load_ushort v24, v5, s[8:11], s37 offen offset:0
    buffer_load_ushort v25, v5, s[8:11], s37 offen offset:256
    buffer_load_ushort v26, v5, s[8:11], s37 offen offset:512
    buffer_load_ushort v27, v5, s[8:11], s37 offen offset:768
    buffer_load_ushort v28, v5, s[8:11], s37 offen offset:1024
    buffer_load_ushort v29, v5, s[8:11], s37 offen offset:1280
    buffer_load_ushort v30, v5, s[8:11], s37 offen offset:1536
    buffer_load_ushort v31, v5, s[8:11], s37 offen offset:1792
    s_add_u32 s35, s34, 36
    s_lshl_b32 s46, s35, 10
    s_add_u32 s46, s46, 16252928
    s_cmp_ge_u32 s35, 32
    s_cselect_b32 s8, s4, s24
    s_cselect_b32 s9, s5, s25
    s_and_b32 s37, s35, 3
    s_lshl_b32 s37, s37, 13
    s_bfe_u32 s38, s35, 0x10004
    s_lshl_b32 s38, s38, 7
    s_bfe_u32 s39, s35, 0x20002
    s_lshl_b32 s39, s39, 1
    s_add_u32 s37, s37, s38
    s_add_u32 s37, s37, s39
    buffer_load_ushort v32, v5, s[8:11], s37 offen offset:0
    buffer_load_ushort v33, v5, s[8:11], s37 offen offset:256
    buffer_load_ushort v34, v5, s[8:11], s37 offen offset:512
    buffer_load_ushort v35, v5, s[8:11], s37 offen offset:768
    buffer_load_ushort v36, v5, s[8:11], s37 offen offset:1024
    buffer_load_ushort v37, v5, s[8:11], s37 offen offset:1280
    buffer_load_ushort v38, v5, s[8:11], s37 offen offset:1536
    buffer_load_ushort v39, v5, s[8:11], s37 offen offset:1792
    s_barrier
    s_cmp_ge_u32 s34, 10
    s_cbranch_scc1 K_PC
    s_add_u32 s35, s34, 54
    s_lshl_b32 s47, s35, 10
    s_add_u32 s47, s47, 16252928
    s_cmp_ge_u32 s35, 32
    s_cselect_b32 s8, s4, s24
    s_cselect_b32 s9, s5, s25
    s_and_b32 s37, s35, 3
    s_lshl_b32 s37, s37, 13
    s_bfe_u32 s38, s35, 0x10004
    s_lshl_b32 s38, s38, 7
    s_bfe_u32 s39, s35, 0x20002
    s_lshl_b32 s39, s39, 1
    s_add_u32 s37, s37, s38
    s_add_u32 s37, s37, s39
    buffer_load_ushort v40, v5, s[8:11], s37 offen offset:0
    buffer_load_ushort v41, v5, s[8:11], s37 offen offset:256
    buffer_load_ushort v42, v5, s[8:11], s37 offen offset:512
    buffer_load_ushort v43, v5, s[8:11], s37 offen offset:768
    buffer_load_ushort v44, v5, s[8:11], s37 offen offset:1024
    buffer_load_ushort v45, v5, s[8:11], s37 offen offset:1280
    buffer_load_ushort v46, v5, s[8:11], s37 offen offset:1536
    buffer_load_ushort v47, v5, s[8:11], s37 offen offset:1792
    s_waitcnt vmcnt(0)
    v_lshl_or_b32 v60, v41, 16, v40
    v_lshl_or_b32 v61, v43, 16, v42
    v_lshl_or_b32 v62, v45, 16, v44
    v_lshl_or_b32 v63, v47, 16, v46
    buffer_store_dwordx4 v[60:63], v6, s[20:23], s47 offen sc1
    s_branch K_PW
K_PC:
    s_sub_u32 s35, s34, 10
    s_lshr_b32 s38, s35, 2
    s_lshl_b32 s38, s38, 7
    s_and_b32 s39, s35, 3
    s_lshl_b32 s39, s39, 1
    s_add_u32 s37, s38, s39
    s_add_u32 s37, s37, 65536
    s_lshl_b32 s38, s35, 9
    s_add_u32 s38, s38, 16318464
    s_mov_b32 s39, 3216550459
    buffer_load_ushort v40, v7, s[24:27], s37 offen offset:0
    buffer_load_ushort v41, v7, s[24:27], s37 offen offset:256
    buffer_load_ushort v42, v7, s[24:27], s37 offen offset:512
    buffer_load_ushort v43, v7, s[24:27], s37 offen offset:768
    s_waitcnt vmcnt(0)
    v_lshlrev_b32 v40, 16, v40
    v_lshlrev_b32 v41, 16, v41
    v_lshlrev_b32 v42, 16, v42
    v_lshlrev_b32 v43, 16, v43
    v_mul_f32 v40, s39, v40
    v_mul_f32 v41, s39, v41
    v_mul_f32 v42, s39, v42
    v_mul_f32 v43, s39, v43
    v_cvt_pk_bf16_f32 v60, v40, v41
    v_cvt_pk_bf16_f32 v61, v42, v43
    buffer_store_dwordx2 v[60:61], v8, s[20:23], s38 offen sc1
K_PW:
    v_lshl_or_b32 v48, v17, 16, v16
    v_lshl_or_b32 v49, v19, 16, v18
    v_lshl_or_b32 v50, v21, 16, v20
    v_lshl_or_b32 v51, v23, 16, v22
    buffer_store_dwordx4 v[48:51], v6, s[20:23], s44 offen sc1
    v_lshl_or_b32 v52, v25, 16, v24
    v_lshl_or_b32 v53, v27, 16, v26
    v_lshl_or_b32 v54, v29, 16, v28
    v_lshl_or_b32 v55, v31, 16, v30
    buffer_store_dwordx4 v[52:55], v6, s[20:23], s45 offen sc1
    v_lshl_or_b32 v56, v33, 16, v32
    v_lshl_or_b32 v57, v35, 16, v34
    v_lshl_or_b32 v58, v37, 16, v36
    v_lshl_or_b32 v59, v39, 16, v38
    buffer_store_dwordx4 v[56:59], v6, s[20:23], s46 offen sc1
K_PEND:
    v_mov_b32 v30, 162816
    v_mov_b32 v31, 1
    s_mov_b64 exec, 1
    ds_add_u32 v30, v31 offset:12
    s_mov_b64 exec, -1
    s_mov_b32 s39, 2
    s_branch K_PUB
K_G2:
    v_mov_b32 v14, 162816
    v_mov_b32 v15, 1
    s_mov_b64 exec, 1
    ds_add_u32 v14, v15 offset:32
    s_mov_b64 exec, -1
    s_add_u32 s39, s39, 16777216
    s_add_u32 s16, s82, s39
    s_addc_u32 s17, s83, 0
    s_mov_b32 s18, 51200
    s_mov_b32 s19, 0x20000
    s_cmp_lt_u32 s2, 250
    s_cselect_b32 s18, s18, 0
    s_lshl_b32 s39, s36, 1
    s_add_u32 s12, s82, s39
    s_addc_u32 s13, s83, 0
    s_mov_b32 s14, 50176
    s_mov_b32 s15, 0x20000
    s_sub_u32 s38, 12800000, s39
    s_min_u32 s14, s14, s38
    v_bfe_u32 v18, v2, 2, 2
    v_bfe_u32 v19, v2, 4, 1
    v_bfe_u32 v20, v2, 1, 1
    v_lshl_add_u32 v19, v19, 1, v20
    s_lshl_b32 s37, s34, 2
    v_add_u32 v19, s37, v19
    v_lshlrev_b32 v20, 2, v18
    v_xor_b32 v19, v19, v20
    v_lshrrev_b32 v21, 5, v2
    v_lshl_add_u32 v20, v21, 3, v18
    v_lshlrev_b32 v20, 8, v20
    v_lshl_add_u32 v20, v19, 4, v20
    v_and_b32 v19, 1, v2
    v_lshl_add_u32 v8, v19, 3, v20
    v_and_b32 v18, 31, v2
    v_xor_b32 v22, v21, v18
    v_and_b32 v22, 15, v22
    v_lshlrev_b32 v22, 4, v22
    v_lshl_add_u32 v22, v18, 8, v22
    v_add_u32 v22, 65536, v22
    v_lshrrev_b32 v11, 3, v2
    v_lshlrev_b32 v11, 9, v11
    v_and_b32 v19, 7, v2
    v_lshl_add_u32 v11, v19, 4, v11
    s_lshl_b32 s37, s34, 7
    v_add_u32 v11, s37, v11
    s_lshl_b32 s37, s34, 12
    s_add_u32 s37, s37, 25856
    v_lshl_add_u32 v10, v2, 4, s37
    v_lshlrev_b32 v9, 9, v21
    v_lshl_add_u32 v9, v18, 2, v9
    v_add_u32 v9, s37, v9
    s_mov_b32 s44, 3216550459
    s_mov_b32 s45, 0x7fff0000
    s_mov_b32 s46, 0xffff
    v_xor_b32 v24, 0, v22
    v_xor_b32 v25, 32, v22
    v_xor_b32 v26, 64, v22
    v_xor_b32 v27, 96, v22
    v_xor_b32 v28, 128, v22
    v_xor_b32 v29, 160, v22
    v_xor_b32 v30, 192, v22
    v_xor_b32 v31, 224, v22
    s_cmp_ge_u32 s2, 250
    s_cbranch_scc1 K_NOEP
    v_and_b32 v13, 255, v250
    v_lshlrev_b32 v12, 4, v13
    v_lshrrev_b32 v14, 5, v12
    v_lshlrev_b32 v14, 2, v14
    v_add_u32 v14, 103680, v14
    v_and_b32 v15, 16, v12
    v_mov_b32 v16, 162816
    s_mov_b32 s38, 524288
K_WE0:
    ds_read_b32 v17, v16 offset:48
    s_waitcnt lgkmcnt(0)
    v_readfirstlane_b32 s37, v17
    s_cmp_ge_u32 s37, 2
    s_cbranch_scc1 K_WE0_OK
    s_sleep 1
    s_sub_u32 s38, s38, 1
    s_cmp_lg_u32 s38, 0
    s_cbranch_scc1 K_WE0
K_WE0_OK:
    ds_read_b32 v32, v14 offset:0
    ds_read_b32 v33, v14 offset:512
    ds_read_b32 v34, v14 offset:1024
    ds_read_b32 v35, v14 offset:1536
    ds_read_b32 v36, v14 offset:2048
    ds_read_b32 v37, v14 offset:2560
    s_waitcnt lgkmcnt(0)
    v_add_u32 v32, v32, v15
    ds_read_b128 v[64:67], v32
    v_add_u32 v33, v33, v15
    ds_read_b128 v[68:71], v33
    v_add_u32 v34, v34, v15
    ds_read_b128 v[72:75], v34
    v_add_u32 v35, v35, v15
    ds_read_b128 v[76:79], v35
    v_add_u32 v36, v36, v15
    ds_read_b128 v[80:83], v36
    v_add_u32 v37, v37, v15
    ds_read_b128 v[84:87], v37
    v_add_u32 v13, 0, v12
    s_waitcnt lgkmcnt(5)
    buffer_store_dwordx4 v[64:67], v13, s[16:19], 0 offen sc1
    v_add_u32 v13, 4096, v12
    s_waitcnt lgkmcnt(4)
    buffer_store_dwordx4 v[68:71], v13, s[16:19], 0 offen sc1
    v_add_u32 v13, 8192, v12
    s_waitcnt lgkmcnt(3)
    buffer_store_dwordx4 v[72:75], v13, s[16:19], 0 offen sc1
    v_add_u32 v13, 12288, v12
    s_waitcnt lgkmcnt(2)
    buffer_store_dwordx4 v[76:79], v13, s[16:19], 0 offen sc1
    v_add_u32 v13, 16384, v12
    s_waitcnt lgkmcnt(1)
    buffer_store_dwordx4 v[80:83], v13, s[16:19], 0 offen sc1
    v_add_u32 v13, 20480, v12
    s_waitcnt lgkmcnt(0)
    buffer_store_dwordx4 v[84:87], v13, s[16:19], 0 offen sc1
    s_waitcnt vmcnt(6)
    s_branch K_EPD
K_NOEP:
    s_waitcnt vmcnt(0)
K_EPD:
    v_mov_b32 v14, 162816
    v_mov_b32 v15, 1
    s_mov_b64 exec, 1
    ds_add_u32 v14, v15 offset:24
    s_mov_b64 exec, -1
    v_mov_b32 v14, 162816
    s_mov_b32 s38, 524288
K_WX:
    ds_read_b32 v15, v14 offset:24
    s_waitcnt lgkmcnt(0)
    v_readfirstlane_b32 s37, v15
    s_cmp_ge_u32 s37, 4
    s_cbranch_scc1 K_WX_OK
    s_sleep 1
    s_sub_u32 s38, s38, 1
    s_cmp_lg_u32 s38, 0
    s_cbranch_scc1 K_WX
K_WX_OK:
    ds_read_b128 v[32:35], v24 offset:0
    ds_read_b128 v[36:39], v25 offset:0
    ds_read_b128 v[40:43], v26 offset:0
    ds_read_b128 v[44:47], v27 offset:0
    ds_read_b128 v[48:51], v28 offset:0
    ds_read_b128 v[52:55], v29 offset:0
    ds_read_b128 v[56:59], v30 offset:0
    ds_read_b128 v[60:63], v31 offset:0
    ds_read_b64_tr_b16 v[64:65], v8 offset:0
    ds_read_b64_tr_b16 v[66:67], v8 offset:1024
    ds_read_b64_tr_b16 v[96:97], v8 offset:32768
    ds_read_b64_tr_b16 v[98:99], v8 offset:33792
    ds_read_b64_tr_b16 v[68:69], v8 offset:4096
    ds_read_b64_tr_b16 v[70:71], v8 offset:5120
    ds_read_b64_tr_b16 v[100:101], v8 offset:36864
    ds_read_b64_tr_b16 v[102:103], v8 offset:37888
    s_waitcnt lgkmcnt(4)
    v_mfma_f32_32x32x16_bf16 v[128:143], v[32:35], v[64:67], 0
    v_mfma_f32_32x32x16_bf16 v[144:159], v[32:35], v[96:99], 0
    ds_read_b64_tr_b16 v[72:73], v8 offset:8192
    ds_read_b64_tr_b16 v[74:75], v8 offset:9216
    ds_read_b64_tr_b16 v[104:105], v8 offset:40960
    ds_read_b64_tr_b16 v[106:107], v8 offset:41984
    s_waitcnt lgkmcnt(4)
    v_mfma_f32_32x32x16_bf16 v[128:143], v[36:39], v[68:71], v[128:143]
    v_mfma_f32_32x32x16_bf16 v[144:159], v[36:39], v[100:103], v[144:159]
    ds_read_b64_tr_b16 v[76:77], v8 offset:12288
    ds_read_b64_tr_b16 v[78:79], v8 offset:13312
    ds_read_b64_tr_b16 v[108:109], v8 offset:45056
    ds_read_b64_tr_b16 v[110:111], v8 offset:46080
    s_waitcnt lgkmcnt(4)
    v_mfma_f32_32x32x16_bf16 v[128:143], v[40:43], v[72:75], v[128:143]
    v_mfma_f32_32x32x16_bf16 v[144:159], v[40:43], v[104:107], v[144:159]
    ds_read_b64_tr_b16 v[80:81], v8 offset:16384
    ds_read_b64_tr_b16 v[82:83], v8 offset:17408
    ds_read_b64_tr_b16 v[112:113], v8 offset:49152
    ds_read_b64_tr_b16 v[114:115], v8 offset:50176
    s_waitcnt lgkmcnt(4)
    v_mfma_f32_32x32x16_bf16 v[128:143], v[44:47], v[76:79], v[128:143]
    v_mfma_f32_32x32x16_bf16 v[144:159], v[44:47], v[108:111], v[144:159]
    ds_read_b64_tr_b16 v[84:85], v8 offset:20480
    ds_read_b64_tr_b16 v[86:87], v8 offset:21504
    ds_read_b64_tr_b16 v[116:117], v8 offset:53248
    ds_read_b64_tr_b16 v[118:119], v8 offset:54272
    s_waitcnt lgkmcnt(4)
    v_mfma_f32_32x32x16_bf16 v[128:143], v[48:51], v[80:83], v[128:143]
    v_mfma_f32_32x32x16_bf16 v[144:159], v[48:51], v[112:115], v[144:159]
    ds_read_b64_tr_b16 v[88:89], v8 offset:24576
    ds_read_b64_tr_b16 v[90:91], v8 offset:25600
    ds_read_b64_tr_b16 v[120:121], v8 offset:57344
    ds_read_b64_tr_b16 v[122:123], v8 offset:58368
    s_waitcnt lgkmcnt(4)
    v_mfma_f32_32x32x16_bf16 v[128:143], v[52:55], v[84:87], v[128:143]
    v_mfma_f32_32x32x16_bf16 v[144:159], v[52:55], v[116:119], v[144:159]
    ds_read_b64_tr_b16 v[92:93], v8 offset:28672
    ds_read_b64_tr_b16 v[94:95], v8 offset:29696
    ds_read_b64_tr_b16 v[124:125], v8 offset:61440
    ds_read_b64_tr_b16 v[126:127], v8 offset:62464
    s_waitcnt lgkmcnt(4)
    v_mfma_f32_32x32x16_bf16 v[128:143], v[56:59], v[88:91], v[128:143]
    v_mfma_f32_32x32x16_bf16 v[144:159], v[56:59], v[120:123], v[144:159]
    s_waitcnt lgkmcnt(0)
    v_mov_b32 v14, 162816
    v_mov_b32 v15, 1
    s_mov_b64 exec, 1
    ds_add_u32 v14, v15 offset:28
    s_mov_b64 exec, -1
    ds_read_b128 v[192:195], v24 offset:8192
    ds_read_b128 v[196:199], v25 offset:8192
    ds_read_b128 v[200:203], v26 offset:8192
    ds_read_b128 v[204:207], v27 offset:8192
    ds_read_b128 v[208:211], v28 offset:8192
    ds_read_b128 v[212:215], v29 offset:8192
    ds_read_b128 v[216:219], v30 offset:8192
    ds_read_b128 v[220:223], v31 offset:8192
    v_mfma_f32_32x32x16_bf16 v[128:143], v[60:63], v[92:95], v[128:143]
    v_mfma_f32_32x32x16_bf16 v[144:159], v[60:63], v[124:127], v[144:159]
    v_mov_b32 v16, 162816
    s_mov_b32 s38, 524288
K_WD:
    ds_read_b32 v17, v16 offset:28
    s_waitcnt lgkmcnt(0)
    v_readfirstlane_b32 s37, v17
    s_cmp_ge_u32 s37, 4
    s_cbranch_scc1 K_WD_OK
    s_sleep 1
    s_sub_u32 s38, s38, 1
    s_cmp_lg_u32 s38, 0
    s_cbranch_scc1 K_WD
K_WD_OK:
    s_waitcnt lgkmcnt(0)
    v_mfma_f32_32x32x16_bf16 v[160:175], v[192:195], v[64:67], 0
    v_mfma_f32_32x32x16_bf16 v[176:191], v[192:195], v[96:99], 0
    s_nop 7
    v_mul_f32 v128, s44, v128
    v_and_b32 v14, 0x7fffffff, v144
    v_cvt_f16_f32 v128, v128
    v_add_u32 v14, 0x8000, v14
    v_and_b32 v128, 0xffff, v128
    v_sub_u32_e64 v14, v14, v128 clamp
    v_bfi_b32 v14, s45, v14, v144
    v_bfi_b32 v128, s46, v128, v14
    ds_write_b32 v9, v128 offset:0
    v_mul_f32 v129, s44, v129
    v_mfma_f32_32x32x16_bf16 v[160:175], v[196:199], v[68:71], v[160:175]
    v_and_b32 v15, 0x7fffffff, v145
    v_cvt_f16_f32 v129, v129
    v_add_u32 v15, 0x8000, v15
    v_and_b32 v129, 0xffff, v129
    v_sub_u32_e64 v15, v15, v129 clamp
    v_bfi_b32 v15, s45, v15, v145
    v_bfi_b32 v129, s46, v129, v15
    ds_write_b32 v9, v129 offset:128
    v_mul_f32 v130, s44, v130
    v_and_b32 v14, 0x7fffffff, v146
    v_mfma_f32_32x32x16_bf16 v[176:191], v[196:199], v[100:103], v[176:191]
    v_cvt_f16_f32 v130, v130
    v_add_u32 v14, 0x8000, v14
    v_and_b32 v130, 0xffff, v130
    v_sub_u32_e64 v14, v14, v130 clamp
    v_bfi_b32 v14, s45, v14, v146
    v_bfi_b32 v130, s46, v130, v14
    ds_write_b32 v9, v130 offset:256
    v_mul_f32 v131, s44, v131
    v_and_b32 v15, 0x7fffffff, v147
    v_cvt_f16_f32 v131, v131
    v_mfma_f32_32x32x16_bf16 v[160:175], v[200:203], v[72:75], v[160:175]
    v_add_u32 v15, 0x8000, v15
    v_and_b32 v131, 0xffff, v131
    v_sub_u32_e64 v15, v15, v131 clamp
    v_bfi_b32 v15, s45, v15, v147
    v_bfi_b32 v131, s46, v131, v15
    ds_write_b32 v9, v131 offset:384
    v_mul_f32 v132, s44, v132
    v_and_b32 v14, 0x7fffffff, v148
    v_cvt_f16_f32 v132, v132
    v_add_u32 v14, 0x8000, v14
    v_mfma_f32_32x32x16_bf16 v[176:191], v[200:203], v[104:107], v[176:191]
    v_and_b32 v132, 0xffff, v132
    v_sub_u32_e64 v14, v14, v132 clamp
    v_bfi_b32 v14, s45, v14, v148
    v_bfi_b32 v132, s46, v132, v14
    ds_write_b32 v9, v132 offset:1024
    v_mul_f32 v133, s44, v133
    v_and_b32 v15, 0x7fffffff, v149
    v_cvt_f16_f32 v133, v133
    v_add_u32 v15, 0x8000, v15
    v_and_b32 v133, 0xffff, v133
    v_mfma_f32_32x32x16_bf16 v[160:175], v[204:207], v[76:79], v[160:175]
    v_sub_u32_e64 v15, v15, v133 clamp
    v_bfi_b32 v15, s45, v15, v149
    v_bfi_b32 v133, s46, v133, v15
    ds_write_b32 v9, v133 offset:1152
    v_mul_f32 v134, s44, v134
    v_and_b32 v14, 0x7fffffff, v150
    v_cvt_f16_f32 v134, v134
    v_add_u32 v14, 0x8000, v14
    v_and_b32 v134, 0xffff, v134
    v_sub_u32_e64 v14, v14, v134 clamp
    v_mfma_f32_32x32x16_bf16 v[176:191], v[204:207], v[108:111], v[176:191]
    v_bfi_b32 v14, s45, v14, v150
    v_bfi_b32 v134, s46, v134, v14
    ds_write_b32 v9, v134 offset:1280
    v_mul_f32 v135, s44, v135
    v_and_b32 v15, 0x7fffffff, v151
    v_cvt_f16_f32 v135, v135
    v_add_u32 v15, 0x8000, v15
    v_and_b32 v135, 0xffff, v135
    v_sub_u32_e64 v15, v15, v135 clamp
    v_bfi_b32 v15, s45, v15, v151
    v_mfma_f32_32x32x16_bf16 v[160:175], v[208:211], v[80:83], v[160:175]
    v_bfi_b32 v135, s46, v135, v15
    ds_write_b32 v9, v135 offset:1408
    v_mul_f32 v136, s44, v136
    v_and_b32 v14, 0x7fffffff, v152
    v_cvt_f16_f32 v136, v136
    v_add_u32 v14, 0x8000, v14
    v_and_b32 v136, 0xffff, v136
    v_sub_u32_e64 v14, v14, v136 clamp
    v_bfi_b32 v14, s45, v14, v152
    v_bfi_b32 v136, s46, v136, v14
    v_mfma_f32_32x32x16_bf16 v[176:191], v[208:211], v[112:115], v[176:191]
    ds_write_b32 v9, v136 offset:2048
    v_mul_f32 v137, s44, v137
    v_and_b32 v15, 0x7fffffff, v153
    v_cvt_f16_f32 v137, v137
    v_add_u32 v15, 0x8000, v15
    v_and_b32 v137, 0xffff, v137
    v_sub_u32_e64 v15, v15, v137 clamp
    v_bfi_b32 v15, s45, v15, v153
    v_bfi_b32 v137, s46, v137, v15
    ds_write_b32 v9, v137 offset:2176
    v_mfma_f32_32x32x16_bf16 v[160:175], v[212:215], v[84:87], v[160:175]
    v_mul_f32 v138, s44, v138
    v_and_b32 v14, 0x7fffffff, v154
    v_cvt_f16_f32 v138, v138
    v_add_u32 v14, 0x8000, v14
    v_and_b32 v138, 0xffff, v138
    v_sub_u32_e64 v14, v14, v138 clamp
    v_bfi_b32 v14, s45, v14, v154
    v_bfi_b32 v138, s46, v138, v14
    ds_write_b32 v9, v138 offset:2304
    v_mul_f32 v139, s44, v139
    v_mfma_f32_32x32x16_bf16 v[176:191], v[212:215], v[116:119], v[176:191]
    v_and_b32 v15, 0x7fffffff, v155
    v_cvt_f16_f32 v139, v139
    v_add_u32 v15, 0x8000, v15
    v_and_b32 v139, 0xffff, v139
    v_sub_u32_e64 v15, v15, v139 clamp
    v_bfi_b32 v15, s45, v15, v155
    v_bfi_b32 v139, s46, v139, v15
    ds_write_b32 v9, v139 offset:2432
    v_mul_f32 v140, s44, v140
    v_and_b32 v14, 0x7fffffff, v156
    v_mfma_f32_32x32x16_bf16 v[160:175], v[216:219], v[88:91], v[160:175]
    v_cvt_f16_f32 v140, v140
    v_add_u32 v14, 0x8000, v14
    v_and_b32 v140, 0xffff, v140
    v_sub_u32_e64 v14, v14, v140 clamp
    v_bfi_b32 v14, s45, v14, v156
    v_bfi_b32 v140, s46, v140, v14
    ds_write_b32 v9, v140 offset:3072
    v_mul_f32 v141, s44, v141
    v_and_b32 v15, 0x7fffffff, v157
    v_cvt_f16_f32 v141, v141
    v_mfma_f32_32x32x16_bf16 v[176:191], v[216:219], v[120:123], v[176:191]
    v_add_u32 v15, 0x8000, v15
    v_and_b32 v141, 0xffff, v141
    v_sub_u32_e64 v15, v15, v141 clamp
    v_bfi_b32 v15, s45, v15, v157
    v_bfi_b32 v141, s46, v141, v15
    ds_write_b32 v9, v141 offset:3200
    v_mul_f32 v142, s44, v142
    v_and_b32 v14, 0x7fffffff, v158
    v_cvt_f16_f32 v142, v142
    v_add_u32 v14, 0x8000, v14
    v_mfma_f32_32x32x16_bf16 v[160:175], v[220:223], v[92:95], v[160:175]
    v_and_b32 v142, 0xffff, v142
    v_sub_u32_e64 v14, v14, v142 clamp
    v_bfi_b32 v14, s45, v14, v158
    v_bfi_b32 v142, s46, v142, v14
    ds_write_b32 v9, v142 offset:3328
    v_mul_f32 v143, s44, v143
    v_and_b32 v15, 0x7fffffff, v159
    v_cvt_f16_f32 v143, v143
    v_add_u32 v15, 0x8000, v15
    v_and_b32 v143, 0xffff, v143
    v_mfma_f32_32x32x16_bf16 v[176:191], v[220:223], v[124:127], v[176:191]
    v_sub_u32_e64 v15, v15, v143 clamp
    v_bfi_b32 v15, s45, v15, v159
    v_bfi_b32 v143, s46, v143, v15
    ds_write_b32 v9, v143 offset:3456
    ds_read_b128 v[32:35], v24 offset:16384
    ds_read_b128 v[36:39], v25 offset:16384
    ds_read_b128 v[40:43], v26 offset:16384
    ds_read_b128 v[44:47], v27 offset:16384
    ds_read_b128 v[48:51], v28 offset:16384
    ds_read_b128 v[52:55], v29 offset:16384
    ds_read_b128 v[56:59], v30 offset:16384
    ds_read_b128 v[60:63], v31 offset:16384
    s_nop 0
    ds_read_b128 v[224:227], v10 offset:0
    ds_read_b128 v[228:231], v10 offset:1024
    ds_read_b128 v[232:235], v10 offset:2048
    ds_read_b128 v[236:239], v10 offset:3072
    v_add_u32 v16, 0, v11
    s_waitcnt vmcnt(63) lgkmcnt(3)
    buffer_store_dwordx4 v[224:227], v16, s[12:15], 0 offen sc1
    v_add_u32 v16, 4096, v11
    s_waitcnt vmcnt(63) lgkmcnt(2)
    buffer_store_dwordx4 v[228:231], v16, s[12:15], 0 offen sc1
    v_add_u32 v16, 8192, v11
    s_waitcnt vmcnt(63) lgkmcnt(1)
    buffer_store_dwordx4 v[232:235], v16, s[12:15], 0 offen sc1
    v_add_u32 v16, 12288, v11
    s_waitcnt vmcnt(63) lgkmcnt(0)
    buffer_store_dwordx4 v[236:239], v16, s[12:15], 0 offen sc1
    s_waitcnt lgkmcnt(0)
    v_mfma_f32_32x32x16_bf16 v[128:143], v[32:35], v[64:67], 0
    v_mfma_f32_32x32x16_bf16 v[144:159], v[32:35], v[96:99], 0
    v_mul_f32 v160, s44, v160
    v_and_b32 v14, 0x7fffffff, v176
    v_cvt_f16_f32 v160, v160
    v_add_u32 v14, 0x8000, v14
    v_and_b32 v160, 0xffff, v160
    v_sub_u32_e64 v14, v14, v160 clamp
    v_bfi_b32 v14, s45, v14, v176
    v_bfi_b32 v160, s46, v160, v14
    ds_write_b32 v9, v160 offset:0
    v_mul_f32 v161, s44, v161
    v_mfma_f32_32x32x16_bf16 v[128:143], v[36:39], v[68:71], v[128:143]
    v_and_b32 v15, 0x7fffffff, v177
    v_cvt_f16_f32 v161, v161
    v_add_u32 v15, 0x8000, v15
    v_and_b32 v161, 0xffff, v161
    v_sub_u32_e64 v15, v15, v161 clamp
    v_bfi_b32 v15, s45, v15, v177
    v_bfi_b32 v161, s46, v161, v15
    ds_write_b32 v9, v161 offset:128
    v_mul_f32 v162, s44, v162
    v_and_b32 v14, 0x7fffffff, v178
    v_mfma_f32_32x32x16_bf16 v[144:159], v[36:39], v[100:103], v[144:159]
    v_cvt_f16_f32 v162, v162
    v_add_u32 v14, 0x8000, v14
    v_and_b32 v162, 0xffff, v162
    v_sub_u32_e64 v14, v14, v162 clamp
    v_bfi_b32 v14, s45, v14, v178
    v_bfi_b32 v162, s46, v162, v14
    ds_write_b32 v9, v162 offset:256
    v_mul_f32 v163, s44, v163
    v_and_b32 v15, 0x7fffffff, v179
    v_cvt_f16_f32 v163, v163
    v_mfma_f32_32x32x16_bf16 v[128:143], v[40:43], v[72:75], v[128:143]
    v_add_u32 v15, 0x8000, v15
    v_and_b32 v163, 0xffff, v163
    v_sub_u32_e64 v15, v15, v163 clamp
    v_bfi_b32 v15, s45, v15, v179
    v_bfi_b32 v163, s46, v163, v15
    ds_write_b32 v9, v163 offset:384
    v_mul_f32 v164, s44, v164
    v_and_b32 v14, 0x7fffffff, v180
    v_cvt_f16_f32 v164, v164
    v_add_u32 v14, 0x8000, v14
    v_mfma_f32_32x32x16_bf16 v[144:159], v[40:43], v[104:107], v[144:159]
    v_and_b32 v164, 0xffff, v164
    v_sub_u32_e64 v14, v14, v164 clamp
    v_bfi_b32 v14, s45, v14, v180
    v_bfi_b32 v164, s46, v164, v14
    ds_write_b32 v9, v164 offset:1024
    v_mul_f32 v165, s44, v165
    v_and_b32 v15, 0x7fffffff, v181
    v_cvt_f16_f32 v165, v165
    v_add_u32 v15, 0x8000, v15
    v_and_b32 v165, 0xffff, v165
    v_mfma_f32_32x32x16_bf16 v[128:143], v[44:47], v[76:79], v[128:143]
    v_sub_u32_e64 v15, v15, v165 clamp
    v_bfi_b32 v15, s45, v15, v181
    v_bfi_b32 v165, s46, v165, v15
    ds_write_b32 v9, v165 offset:1152
    v_mul_f32 v166, s44, v166
    v_and_b32 v14, 0x7fffffff, v182
    v_cvt_f16_f32 v166, v166
    v_add_u32 v14, 0x8000, v14
    v_and_b32 v166, 0xffff, v166
    v_sub_u32_e64 v14, v14, v166 clamp
    v_mfma_f32_32x32x16_bf16 v[144:159], v[44:47], v[108:111], v[144:159]
    v_bfi_b32 v14, s45, v14, v182
    v_bfi_b32 v166, s46, v166, v14
    ds_write_b32 v9, v166 offset:1280
    v_mul_f32 v167, s44, v167
    v_and_b32 v15, 0x7fffffff, v183
    v_cvt_f16_f32 v167, v167
    v_add_u32 v15, 0x8000, v15
    v_and_b32 v167, 0xffff, v167
    v_sub_u32_e64 v15, v15, v167 clamp
    v_bfi_b32 v15, s45, v15, v183
    v_mfma_f32_32x32x16_bf16 v[128:143], v[48:51], v[80:83], v[128:143]
    v_bfi_b32 v167, s46, v167, v15
    ds_write_b32 v9, v167 offset:1408
    v_mul_f32 v168, s44, v168
    v_and_b32 v14, 0x7fffffff, v184
    v_cvt_f16_f32 v168, v168
    v_add_u32 v14, 0x8000, v14
    v_and_b32 v168, 0xffff, v168
    v_sub_u32_e64 v14, v14, v168 clamp
    v_bfi_b32 v14, s45, v14, v184
    v_bfi_b32 v168, s46, v168, v14
    v_mfma_f32_32x32x16_bf16 v[144:159], v[48:51], v[112:115], v[144:159]
    ds_write_b32 v9, v168 offset:2048
    v_mul_f32 v169, s44, v169
    v_and_b32 v15, 0x7fffffff, v185
    v_cvt_f16_f32 v169, v169
    v_add_u32 v15, 0x8000, v15
    v_and_b32 v169, 0xffff, v169
    v_sub_u32_e64 v15, v15, v169 clamp
    v_bfi_b32 v15, s45, v15, v185
    v_bfi_b32 v169, s46, v169, v15
    ds_write_b32 v9, v169 offset:2176
    v_mfma_f32_32x32x16_bf16 v[128:143], v[52:55], v[84:87], v[128:143]
    v_mul_f32 v170, s44, v170
    v_and_b32 v14, 0x7fffffff, v186
    v_cvt_f16_f32 v170, v170
    v_add_u32 v14, 0x8000, v14
    v_and_b32 v170, 0xffff, v170
    v_sub_u32_e64 v14, v14, v170 clamp
    v_bfi_b32 v14, s45, v14, v186
    v_bfi_b32 v170, s46, v170, v14
    ds_write_b32 v9, v170 offset:2304
    v_mul_f32 v171, s44, v171
    v_mfma_f32_32x32x16_bf16 v[144:159], v[52:55], v[116:119], v[144:159]
    v_and_b32 v15, 0x7fffffff, v187
    v_cvt_f16_f32 v171, v171
    v_add_u32 v15, 0x8000, v15
    v_and_b32 v171, 0xffff, v171
    v_sub_u32_e64 v15, v15, v171 clamp
    v_bfi_b32 v15, s45, v15, v187
    v_bfi_b32 v171, s46, v171, v15
    ds_write_b32 v9, v171 offset:2432
    v_mul_f32 v172, s44, v172
    v_and_b32 v14, 0x7fffffff, v188
    v_mfma_f32_32x32x16_bf16 v[128:143], v[56:59], v[88:91], v[128:143]
    v_cvt_f16_f32 v172, v172
    v_add_u32 v14, 0x8000, v14
    v_and_b32 v172, 0xffff, v172
    v_sub_u32_e64 v14, v14, v172 clamp
    v_bfi_b32 v14, s45, v14, v188
    v_bfi_b32 v172, s46, v172, v14
    ds_write_b32 v9, v172 offset:3072
    v_mul_f32 v173, s44, v173
    v_and_b32 v15, 0x7fffffff, v189
    v_cvt_f16_f32 v173, v173
    v_mfma_f32_32x32x16_bf16 v[144:159], v[56:59], v[120:123], v[144:159]
    v_add_u32 v15, 0x8000, v15
    v_and_b32 v173, 0xffff, v173
    v_sub_u32_e64 v15, v15, v173 clamp
    v_bfi_b32 v15, s45, v15, v189
    v_bfi_b32 v173, s46, v173, v15
    ds_write_b32 v9, v173 offset:3200
    v_mul_f32 v174, s44, v174
    v_and_b32 v14, 0x7fffffff, v190
    v_cvt_f16_f32 v174, v174
    v_add_u32 v14, 0x8000, v14
    v_mfma_f32_32x32x16_bf16 v[128:143], v[60:63], v[92:95], v[128:143]
    v_and_b32 v174, 0xffff, v174
    v_sub_u32_e64 v14, v14, v174 clamp
    v_bfi_b32 v14, s45, v14, v190
    v_bfi_b32 v174, s46, v174, v14
    ds_write_b32 v9, v174 offset:3328
    v_mul_f32 v175, s44, v175
    v_and_b32 v15, 0x7fffffff, v191
    v_cvt_f16_f32 v175, v175
    v_add_u32 v15, 0x8000, v15
    v_and_b32 v175, 0xffff, v175
    v_mfma_f32_32x32x16_bf16 v[144:159], v[60:63], v[124:127], v[144:159]
    v_sub_u32_e64 v15, v15, v175 clamp
    v_bfi_b32 v15, s45, v15, v191
    v_bfi_b32 v175, s46, v175, v15
    ds_write_b32 v9, v175 offset:3456
    ds_read_b128 v[192:195], v24 offset:24576
    ds_read_b128 v[196:199], v25 offset:24576
    ds_read_b128 v[200:203], v26 offset:24576
    ds_read_b128 v[204:207], v27 offset:24576
    ds_read_b128 v[208:211], v28 offset:24576
    ds_read_b128 v[212:215], v29 offset:24576
    ds_read_b128 v[216:219], v30 offset:24576
    ds_read_b128 v[220:223], v31 offset:24576
    s_nop 0
    ds_read_b128 v[224:227], v10 offset:0
    ds_read_b128 v[228:231], v10 offset:1024
    ds_read_b128 v[232:235], v10 offset:2048
    ds_read_b128 v[236:239], v10 offset:3072
    v_add_u32 v16, 16384, v11
    s_waitcnt vmcnt(63) lgkmcnt(3)
    buffer_store_dwordx4 v[224:227], v16, s[12:15], 0 offen sc1
    v_add_u32 v16, 20480, v11
    s_waitcnt vmcnt(63) lgkmcnt(2)
    buffer_store_dwordx4 v[228:231], v16, s[12:15], 0 offen sc1
    v_add_u32 v16, 24576, v11
    s_waitcnt vmcnt(63) lgkmcnt(1)
    buffer_store_dwordx4 v[232:235], v16, s[12:15], 0 offen sc1
    v_add_u32 v16, 28672, v11
    s_waitcnt vmcnt(63) lgkmcnt(0)
    buffer_store_dwordx4 v[236:239], v16, s[12:15], 0 offen sc1
    s_waitcnt lgkmcnt(0)
    v_mfma_f32_32x32x16_bf16 v[160:175], v[192:195], v[64:67], 0
    v_mfma_f32_32x32x16_bf16 v[176:191], v[192:195], v[96:99], 0
    v_mul_f32 v128, s44, v128
    v_and_b32 v14, 0x7fffffff, v144
    v_cvt_f16_f32 v128, v128
    v_add_u32 v14, 0x8000, v14
    v_and_b32 v128, 0xffff, v128
    v_sub_u32_e64 v14, v14, v128 clamp
    v_bfi_b32 v14, s45, v14, v144
    v_bfi_b32 v128, s46, v128, v14
    ds_write_b32 v9, v128 offset:0
    v_mul_f32 v129, s44, v129
    v_mfma_f32_32x32x16_bf16 v[160:175], v[196:199], v[68:71], v[160:175]
    v_and_b32 v15, 0x7fffffff, v145
    v_cvt_f16_f32 v129, v129
    v_add_u32 v15, 0x8000, v15
    v_and_b32 v129, 0xffff, v129
    v_sub_u32_e64 v15, v15, v129 clamp
    v_bfi_b32 v15, s45, v15, v145
    v_bfi_b32 v129, s46, v129, v15
    ds_write_b32 v9, v129 offset:128
    v_mul_f32 v130, s44, v130
    v_and_b32 v14, 0x7fffffff, v146
    v_mfma_f32_32x32x16_bf16 v[176:191], v[196:199], v[100:103], v[176:191]
    v_cvt_f16_f32 v130, v130
    v_add_u32 v14, 0x8000, v14
    v_and_b32 v130, 0xffff, v130
    v_sub_u32_e64 v14, v14, v130 clamp
    v_bfi_b32 v14, s45, v14, v146
    v_bfi_b32 v130, s46, v130, v14
    ds_write_b32 v9, v130 offset:256
    v_mul_f32 v131, s44, v131
    v_and_b32 v15, 0x7fffffff, v147
    v_cvt_f16_f32 v131, v131
    v_mfma_f32_32x32x16_bf16 v[160:175], v[200:203], v[72:75], v[160:175]
    v_add_u32 v15, 0x8000, v15
    v_and_b32 v131, 0xffff, v131
    v_sub_u32_e64 v15, v15, v131 clamp
    v_bfi_b32 v15, s45, v15, v147
    v_bfi_b32 v131, s46, v131, v15
    ds_write_b32 v9, v131 offset:384
    v_mul_f32 v132, s44, v132
    v_and_b32 v14, 0x7fffffff, v148
    v_cvt_f16_f32 v132, v132
    v_add_u32 v14, 0x8000, v14
    v_mfma_f32_32x32x16_bf16 v[176:191], v[200:203], v[104:107], v[176:191]
    v_and_b32 v132, 0xffff, v132
    v_sub_u32_e64 v14, v14, v132 clamp
    v_bfi_b32 v14, s45, v14, v148
    v_bfi_b32 v132, s46, v132, v14
    ds_write_b32 v9, v132 offset:1024
    v_mul_f32 v133, s44, v133
    v_and_b32 v15, 0x7fffffff, v149
    v_cvt_f16_f32 v133, v133
    v_add_u32 v15, 0x8000, v15
    v_and_b32 v133, 0xffff, v133
    v_mfma_f32_32x32x16_bf16 v[160:175], v[204:207], v[76:79], v[160:175]
    v_sub_u32_e64 v15, v15, v133 clamp
    v_bfi_b32 v15, s45, v15, v149
    v_bfi_b32 v133, s46, v133, v15
    ds_write_b32 v9, v133 offset:1152
    v_mul_f32 v134, s44, v134
    v_and_b32 v14, 0x7fffffff, v150
    v_cvt_f16_f32 v134, v134
    v_add_u32 v14, 0x8000, v14
    v_and_b32 v134, 0xffff, v134
    v_sub_u32_e64 v14, v14, v134 clamp
    v_mfma_f32_32x32x16_bf16 v[176:191], v[204:207], v[108:111], v[176:191]
    v_bfi_b32 v14, s45, v14, v150
    v_bfi_b32 v134, s46, v134, v14
    ds_write_b32 v9, v134 offset:1280
    v_mul_f32 v135, s44, v135
    v_and_b32 v15, 0x7fffffff, v151
    v_cvt_f16_f32 v135, v135
    v_add_u32 v15, 0x8000, v15
    v_and_b32 v135, 0xffff, v135
    v_sub_u32_e64 v15, v15, v135 clamp
    v_bfi_b32 v15, s45, v15, v151
    v_mfma_f32_32x32x16_bf16 v[160:175], v[208:211], v[80:83], v[160:175]
    v_bfi_b32 v135, s46, v135, v15
    ds_write_b32 v9, v135 offset:1408
    v_mul_f32 v136, s44, v136
    v_and_b32 v14, 0x7fffffff, v152
    v_cvt_f16_f32 v136, v136
    v_add_u32 v14, 0x8000, v14
    v_and_b32 v136, 0xffff, v136
    v_sub_u32_e64 v14, v14, v136 clamp
    v_bfi_b32 v14, s45, v14, v152
    v_bfi_b32 v136, s46, v136, v14
    v_mfma_f32_32x32x16_bf16 v[176:191], v[208:211], v[112:115], v[176:191]
    ds_write_b32 v9, v136 offset:2048
    v_mul_f32 v137, s44, v137
    v_and_b32 v15, 0x7fffffff, v153
    v_cvt_f16_f32 v137, v137
    v_add_u32 v15, 0x8000, v15
    v_and_b32 v137, 0xffff, v137
    v_sub_u32_e64 v15, v15, v137 clamp
    v_bfi_b32 v15, s45, v15, v153
    v_bfi_b32 v137, s46, v137, v15
    ds_write_b32 v9, v137 offset:2176
    v_mfma_f32_32x32x16_bf16 v[160:175], v[212:215], v[84:87], v[160:175]
    v_mul_f32 v138, s44, v138
    v_and_b32 v14, 0x7fffffff, v154
    v_cvt_f16_f32 v138, v138
    v_add_u32 v14, 0x8000, v14
    v_and_b32 v138, 0xffff, v138
    v_sub_u32_e64 v14, v14, v138 clamp
    v_bfi_b32 v14, s45, v14, v154
    v_bfi_b32 v138, s46, v138, v14
    ds_write_b32 v9, v138 offset:2304
    v_mul_f32 v139, s44, v139
    v_mfma_f32_32x32x16_bf16 v[176:191], v[212:215], v[116:119], v[176:191]
    v_and_b32 v15, 0x7fffffff, v155
    v_cvt_f16_f32 v139, v139
    v_add_u32 v15, 0x8000, v15
    v_and_b32 v139, 0xffff, v139
    v_sub_u32_e64 v15, v15, v139 clamp
    v_bfi_b32 v15, s45, v15, v155
    v_bfi_b32 v139, s46, v139, v15
    ds_write_b32 v9, v139 offset:2432
    v_mul_f32 v140, s44, v140
    v_and_b32 v14, 0x7fffffff, v156
    v_mfma_f32_32x32x16_bf16 v[160:175], v[216:219], v[88:91], v[160:175]
    v_cvt_f16_f32 v140, v140
    v_add_u32 v14, 0x8000, v14
    v_and_b32 v140, 0xffff, v140
    v_sub_u32_e64 v14, v14, v140 clamp
    v_bfi_b32 v14, s45, v14, v156
    v_bfi_b32 v140, s46, v140, v14
    ds_write_b32 v9, v140 offset:3072
    v_mul_f32 v141, s44, v141
    v_and_b32 v15, 0x7fffffff, v157
    v_cvt_f16_f32 v141, v141
    v_mfma_f32_32x32x16_bf16 v[176:191], v[216:219], v[120:123], v[176:191]
    v_add_u32 v15, 0x8000, v15
    v_and_b32 v141, 0xffff, v141
    v_sub_u32_e64 v15, v15, v141 clamp
    v_bfi_b32 v15, s45, v15, v157
    v_bfi_b32 v141, s46, v141, v15
    ds_write_b32 v9, v141 offset:3200
    v_mul_f32 v142, s44, v142
    v_and_b32 v14, 0x7fffffff, v158
    v_cvt_f16_f32 v142, v142
    v_add_u32 v14, 0x8000, v14
    v_mfma_f32_32x32x16_bf16 v[160:175], v[220:223], v[92:95], v[160:175]
    v_and_b32 v142, 0xffff, v142
    v_sub_u32_e64 v14, v14, v142 clamp
    v_bfi_b32 v14, s45, v14, v158
    v_bfi_b32 v142, s46, v142, v14
    ds_write_b32 v9, v142 offset:3328
    v_mul_f32 v143, s44, v143
    v_and_b32 v15, 0x7fffffff, v159
    v_cvt_f16_f32 v143, v143
    v_add_u32 v15, 0x8000, v15
    v_and_b32 v143, 0xffff, v143
    v_mfma_f32_32x32x16_bf16 v[176:191], v[220:223], v[124:127], v[176:191]
    v_sub_u32_e64 v15, v15, v143 clamp
    v_bfi_b32 v15, s45, v15, v159
    v_bfi_b32 v143, s46, v143, v15
    ds_write_b32 v9, v143 offset:3456
    ds_read_b128 v[224:227], v10 offset:0
    ds_read_b128 v[228:231], v10 offset:1024
    ds_read_b128 v[232:235], v10 offset:2048
    ds_read_b128 v[236:239], v10 offset:3072
    v_add_u32 v16, 32768, v11
    s_waitcnt vmcnt(63) lgkmcnt(3)
    buffer_store_dwordx4 v[224:227], v16, s[12:15], 0 offen sc1
    v_add_u32 v16, 36864, v11
    s_waitcnt vmcnt(63) lgkmcnt(2)
    buffer_store_dwordx4 v[228:231], v16, s[12:15], 0 offen sc1
    v_add_u32 v16, 40960, v11
    s_waitcnt vmcnt(63) lgkmcnt(1)
    buffer_store_dwordx4 v[232:235], v16, s[12:15], 0 offen sc1
    v_add_u32 v16, 45056, v11
    s_waitcnt vmcnt(63) lgkmcnt(0)
    buffer_store_dwordx4 v[236:239], v16, s[12:15], 0 offen sc1
    s_nop 3
    v_mul_f32 v160, s44, v160
    v_and_b32 v14, 0x7fffffff, v176
    v_cvt_f16_f32 v160, v160
    v_add_u32 v14, 0x8000, v14
    v_and_b32 v160, 0xffff, v160
    v_sub_u32_e64 v14, v14, v160 clamp
    v_bfi_b32 v14, s45, v14, v176
    v_bfi_b32 v160, s46, v160, v14
    ds_write_b32 v9, v160 offset:0
    v_mul_f32 v161, s44, v161
    v_and_b32 v15, 0x7fffffff, v177
    v_cvt_f16_f32 v161, v161
    v_add_u32 v15, 0x8000, v15
    v_and_b32 v161, 0xffff, v161
    v_sub_u32_e64 v15, v15, v161 clamp
    v_bfi_b32 v15, s45, v15, v177
    v_bfi_b32 v161, s46, v161, v15
    ds_write_b32 v9, v161 offset:128
    v_mul_f32 v162, s44, v162
    v_and_b32 v14, 0x7fffffff, v178
    v_cvt_f16_f32 v162, v162
    v_add_u32 v14, 0x8000, v14
    v_and_b32 v162, 0xffff, v162
    v_sub_u32_e64 v14, v14, v162 clamp
    v_bfi_b32 v14, s45, v14, v178
    v_bfi_b32 v162, s46, v162, v14
    ds_write_b32 v9, v162 offset:256
    v_mul_f32 v163, s44, v163
    v_and_b32 v15, 0x7fffffff, v179
    v_cvt_f16_f32 v163, v163
    v_add_u32 v15, 0x8000, v15
    v_and_b32 v163, 0xffff, v163
    v_sub_u32_e64 v15, v15, v163 clamp
    v_bfi_b32 v15, s45, v15, v179
    v_bfi_b32 v163, s46, v163, v15
    ds_write_b32 v9, v163 offset:384
    ds_read_b128 v[224:227], v10 offset:0
    v_add_u32 v16, 49152, v11
    s_waitcnt vmcnt(63) lgkmcnt(0)
    buffer_store_dwordx4 v[224:227], v16, s[12:15], 0 offen sc1
    v_and_b32 v13, 255, v250
    v_lshlrev_b32 v12, 4, v13
    v_lshrrev_b32 v14, 5, v12
    v_lshlrev_b32 v14, 2, v14
    v_add_u32 v14, 103680, v14
    v_and_b32 v15, 16, v12
    v_mov_b32 v16, 162816
    s_mov_b32 s38, 524288
K_WE:
    ds_read_b32 v17, v16 offset:12
    s_waitcnt lgkmcnt(0)
    v_readfirstlane_b32 s37, v17
    s_cmp_ge_u32 s37, 4
    s_cbranch_scc1 K_WE_OK
    s_sleep 1
    s_sub_u32 s38, s38, 1
    s_cmp_lg_u32 s38, 0
    s_cbranch_scc1 K_WE
K_WE_OK:
    ds_read_b32 v38, v14 offset:3072
    ds_read_b32 v39, v14 offset:3584
    ds_read_b32 v40, v14 offset:4096
    ds_read_b32 v41, v14 offset:4608
    ds_read_b32 v42, v14 offset:5120
    ds_read_b32 v43, v14 offset:5632
    ds_read_b32 v44, v14 offset:6144
    s_waitcnt lgkmcnt(0)
    v_add_u32 v38, v38, v15
    ds_read_b128 v[88:91], v38
    v_add_u32 v39, v39, v15
    ds_read_b128 v[92:95], v39
    v_add_u32 v40, v40, v15
    ds_read_b128 v[96:99], v40
    v_add_u32 v41, v41, v15
    ds_read_b128 v[100:103], v41
    v_add_u32 v42, v42, v15
    ds_read_b128 v[104:107], v42
    v_add_u32 v43, v43, v15
    ds_read_b128 v[108:111], v43
    v_add_u32 v44, v44, v15
    ds_read_b128 v[112:115], v44
    v_add_u32 v13, 24576, v12
    s_waitcnt lgkmcnt(6)
    buffer_store_dwordx4 v[88:91], v13, s[16:19], 0 offen sc1
    v_add_u32 v13, 28672, v12
    s_waitcnt lgkmcnt(5)
    buffer_store_dwordx4 v[92:95], v13, s[16:19], 0 offen sc1
    v_add_u32 v13, 32768, v12
    s_waitcnt lgkmcnt(4)
    buffer_store_dwordx4 v[96:99], v13, s[16:19], 0 offen sc1
    v_add_u32 v13, 36864, v12
    s_waitcnt lgkmcnt(3)
    buffer_store_dwordx4 v[100:103], v13, s[16:19], 0 offen sc1
    v_add_u32 v13, 40960, v12
    s_waitcnt lgkmcnt(2)
    buffer_store_dwordx4 v[104:107], v13, s[16:19], 0 offen sc1
    v_add_u32 v13, 45056, v12
    s_waitcnt lgkmcnt(1)
    buffer_store_dwordx4 v[108:111], v13, s[16:19], 0 offen sc1
    v_add_u32 v13, 49152, v12
    s_waitcnt lgkmcnt(0)
    buffer_store_dwordx4 v[112:115], v13, s[16:19], 0 offen sc1
    v_mov_b32 v16, 162816
    s_mov_b32 s38, 524288
K_GN:
    ds_read_b32 v17, v16 offset:20
    s_waitcnt vmcnt(0) lgkmcnt(0)
    v_readfirstlane_b32 s61, v17
    s_cmp_lg_u32 s61, 0
    s_cbranch_scc1 K_GNOK
    s_sleep 1
    s_sub_u32 s38, s38, 1
    s_cmp_lg_u32 s38, 0
    s_cbranch_scc1 K_GN
K_GNOK:
    v_mov_b32 v16, 162816
    v_mov_b32 v17, 1
    s_mov_b64 exec, 1
    ds_add_rtn_u32 v17, v16, v17 offset:16
    s_mov_b64 exec, -1
    s_waitcnt lgkmcnt(0)
    v_readfirstlane_b32 s37, v17
    s_cmp_eq_u32 s37, 3
    s_cbranch_scc0 K_NOS2
    s_lshl_b32 s37, s2, 4
    s_add_u32 s37, s37, 16400384
    v_mov_b32 v16, 0
    v_mov_b32 v17, s61
    s_mov_b64 exec, 1
    buffer_store_dword v17, v16, s[20:23], s37 offen sc1
    s_mov_b64 exec, -1
K_NOS2:
K2_JOIN:
    v_and_b32 v192, 63, v250
    s_waitcnt lgkmcnt(0)
    s_barrier
    s_cmp_eq_u32 s58, 0
    s_cbranch_scc1 K2_NOB
    v_lshlrev_b32 v126, 4, v192
    s_and_b32 s37, s33, 3
    s_lshl_b32 s37, s37, 10
    s_add_u32 s38, s37, 157696
    v_add_u32 v124, s38, v126
    s_add_u32 s37, s37, 16318464
    buffer_load_dwordx4 v[160:163], v126, s[20:23], s37 offen sc1
    s_lshl_b32 s37, s33, 12
    s_add_u32 s38, s37, 92160
    v_add_u32 v125, s38, v126
    s_add_u32 s38, s37, 16252928
    buffer_load_dwordx4 v[128:131], v126, s[20:23], s38 offen offset:0 sc1
    buffer_load_dwordx4 v[132:135], v126, s[20:23], s38 offen offset:1024 sc1
    buffer_load_dwordx4 v[136:139], v126, s[20:23], s38 offen offset:2048 sc1
    buffer_load_dwordx4 v[140:143], v126, s[20:23], s38 offen offset:3072 sc1
    s_add_u32 s38, s37, 16285696
    buffer_load_dwordx4 v[144:147], v126, s[20:23], s38 offen offset:0 sc1
    buffer_load_dwordx4 v[148:151], v126, s[20:23], s38 offen offset:1024 sc1
    buffer_load_dwordx4 v[152:155], v126, s[20:23], s38 offen offset:2048 sc1
    buffer_load_dwordx4 v[156:159], v126, s[20:23], s38 offen offset:3072 sc1
    v_and_b32 v193, 15, v192
    v_lshrrev_b32 v194, 4, v192
    v_lshlrev_b32 v244, 4, v193
    s_mov_b32 s50, 0
    s_mov_b32 s51, -1
    v_lshlrev_b32 v245, 4, v194
    v_mov_b32 v253, -1
    s_mov_b64 exec, s[50:51]
    v_add_u32 v245, 2016, v245
    v_mov_b32 v253, 0x1e0
    s_mov_b64 exec, -1
    v_and_b32 v193, 3, v192
    v_lshlrev_b32 v193, 3, v193
    v_add_u32 v246, 2560, v193
    s_movk_i32 s54, 0x1e0
    s_mov_b32 s55, 0xfffe00
    s_mov_b32 s12, s82
    s_mov_b32 s13, s83
    s_mov_b32 s14, 12800000
    s_mov_b32 s15, 0x20000
    s_add_u32 s16, s82, 16777216
    s_addc_u32 s17, s83, 0
    s_mov_b32 s18, 12800000
    s_mov_b32 s19, 0x20000
    s_add_u32 s28, s78, s36
    s_addc_u32 s29, s79, 0
    s_mov_b32 s30, 25088
    s_mov_b32 s31, 0x20000
    s_sub_u32 s37, 6400000, s36
    s_min_u32 s30, s30, s37
K2_NOB:
    v_mov_b32 v193, 0
    v_and_b32 v195, 7, v192
    v_lshlrev_b32 v194, 2, v195
    ds_read_b32 v212, v194 offset:3104
    ds_read_b32 v213, v193 offset:3072
    s_waitcnt lgkmcnt(0)
    v_readfirstlane_b32 s48, v213
    s_cmp_eq_u32 s58, 0
    s_cbranch_scc1 K2_NOP2
    s_mov_b32 s58, 0
    s_waitcnt vmcnt(8)
    ds_write_b128 v124, v[160:163]
    s_waitcnt vmcnt(7)
    ds_write_b128 v125, v[128:131] offset:0
    s_waitcnt vmcnt(6)
    ds_write_b128 v125, v[132:135] offset:1024
    s_waitcnt vmcnt(5)
    ds_write_b128 v125, v[136:139] offset:2048
    s_waitcnt vmcnt(4)
    ds_write_b128 v125, v[140:143] offset:3072
    s_waitcnt vmcnt(3)
    ds_write_b128 v125, v[144:147] offset:32768
    s_waitcnt vmcnt(2)
    ds_write_b128 v125, v[148:151] offset:33792
    s_waitcnt vmcnt(1)
    ds_write_b128 v125, v[152:155] offset:34816
    s_waitcnt vmcnt(0)
    ds_write_b128 v125, v[156:159] offset:35840
    s_cmp_lg_u32 s33, 0
    s_cbranch_scc1 K2_W2
    v_and_b32 v0, 63, v250
    v_lshlrev_b32 v0, 4, v0
    s_mov_b32 s38, 524288
    s_mov_b32 s39, 16400384
K_P2:
    buffer_load_dword v1, v0, s[20:23], s39 offen offset:0 sc1
    buffer_load_dword v2, v0, s[20:23], s39 offen offset:1024 sc1
    buffer_load_dword v3, v0, s[20:23], s39 offen offset:2048 sc1
    buffer_load_dword v4, v0, s[20:23], s39 offen offset:3072 sc1
    s_waitcnt vmcnt(0)
    v_xor_b32 v1, s61, v1
    v_xor_b32 v2, s61, v2
    v_xor_b32 v3, s61, v3
    v_xor_b32 v4, s61, v4
    v_or3_b32 v1, v1, v2, v3
    v_or_b32 v1, v1, v4
    v_cmp_ne_u32 vcc, 0, v1
    s_cbranch_vccz K_P2_A
    s_sleep 2
    s_sub_u32 s38, s38, 1
    s_cmp_lg_u32 s38, 0
    s_cbranch_scc1 K_P2
K_P2_A:
K_P2_OK:
K2_W2:
    s_mov_b32 s63, 1
    s_branch K2_CHK
K2_NOP2:
    s_mov_b32 s63, 0
K2_CHK:
    s_movk_i32 s37, 1280
    v_cmp_lt_u32 vcc, s37, v212
    s_cbranch_vccz K2_FITS
    s_cmp_eq_u32 s41, 8
    s_cbranch_scc1 K2_FITS
    s_movk_i32 s41, 8
    s_waitcnt vmcnt(0)
    s_branch K2_AGAIN
K2_FITS:
    s_cmp_eq_u32 s42, 0
    s_cbranch_scc1 K2_HAVEG
    v_lshl_add_u32 v214, v212, 3, v195
    s_nop 0
    s_sub_u32 s37, 11, s33
    v_mov_b32_dpp v216, v214 row_ror:1 row_mask:0xf bank_mask:0xf
    v_mov_b32_dpp v217, v214 row_ror:2 row_mask:0xf bank_mask:0xf
    v_mov_b32_dpp v218, v214 row_ror:3 row_mask:0xf bank_mask:0xf
    v_mov_b32_dpp v219, v214 row_ror:4 row_mask:0xf bank_mask:0xf
    v_mov_b32_dpp v220, v214 row_ror:5 row_mask:0xf bank_mask:0xf
    v_mov_b32_dpp v221, v214 row_ror:6 row_mask:0xf bank_mask:0xf
    v_mov_b32_dpp v222, v214 row_ror:7 row_mask:0xf bank_mask:0xf
    v_sub_u32 v216, v214, v216
    v_sub_u32 v217, v214, v217
    v_sub_u32 v218, v214, v218
    v_sub_u32 v219, v214, v219
    v_sub_u32 v220, v214, v220
    v_sub_u32 v221, v214, v221
    v_sub_u32 v222, v214, v222
    v_lshrrev_b32 v216, 31, v216
    v_lshrrev_b32 v217, 31, v217
    v_lshrrev_b32 v218, 31, v218
    v_lshrrev_b32 v219, 31, v219
    v_lshrrev_b32 v220, 31, v220
    v_lshrrev_b32 v221, 31, v221
    v_lshrrev_b32 v222, 31, v222
    v_add3_u32 v215, v216, v217, v218
    v_add3_u32 v215, v215, v219, v220
    v_add3_u32 v215, v215, v221, v222
    s_cmp_lt_u32 s33, 4
    s_cselect_b32 s37, s33, s37
    v_cmp_eq_u32 vcc, s37, v215
    s_nop 0
    s_ff1_i32_b64 s43, vcc
    s_mul_i32 s52, s43, 49
    s_add_u32 s52, s52, 2
    s_lshr_b32 s52, s52, 2
K2_HAVEG:
    v_readlane_b32 s44, v212, s43
    s_mul_i32 s49, s43, 1408
    v_mov_b32 v197, 0x1e0
    v_lshrrev_b32 v198, 4, v192
    v_and_b32 v199, 15, v192
    s_add_u32 s45, s44, 127
    s_lshr_b32 s45, s45, 7
    s_max_u32 s59, s44, 4
    s_sub_u32 s59, s59, 4
    s_bfe_u32 s57, s59, 0x10006
    s_andn2_b32 s59, s59, 63
    s_add_u32 s37, s49, s59
    s_sub_u32 s59, s44, s59
    v_lshl_add_u32 v196, v192, 2, s37
    ds_read2st64_b32 v[200:201], v196 offset0:13 offset1:57
    v_lshlrev_b32 v202, 2, v192
    v_cmp_gt_u32 vcc, s59, v202
    v_and_b32 v203, 12, v202
    v_and_b32 v204, 12, v192
    v_lshl_add_u32 v203, v203, 2, v204
    v_and_b32 v204, 64, v202
    v_add3_u32 v196, v203, v204, s37
    s_add_u32 s59, s59, 15
    s_lshr_b32 s59, s59, 4
    s_add_u32 s37, s49, 3328
    v_lshl_add_u32 v247, v198, 4, s37
    v_and_b32 v249, 0xfc, v192
    v_add_u32 v249, s37, v249
    s_add_u32 s37, s49, 14592
    v_lshl_add_u32 v248, v199, 2, s37
    s_mov_b64 exec, s[50:51]
    v_subrev_u32 v248, 11264, v248
    s_mov_b64 exec, -1
    s_sub_u32 s60, s45, 1
    s_and_b32 s37, s33, 3
    s_lshl_b32 s37, s37, 2
    s_bitcmp1_b32 s33, 2
    s_cselect_b32 s38, 32, 0
    s_add_u32 s37, s37, 3136
    s_add_u32 s37, s37, s38
    v_mov_b32 v254, s37
    s_waitcnt lgkmcnt(0)
    v_cndmask_b32 v200, v197, v200, vcc
    v_cndmask_b32 v201, v193, v201, vcc
    s_mov_b32 exec_hi, 0
    ds_write2st64_b32 v196, v200, v201 offset0:13 offset1:57
    s_mov_b32 exec_hi, -1
    ds_read_b128 v[32:35], v247 offset:0
    ds_read_b128 v[40:43], v247 offset:64
    ds_read2_b32 v[48:49], v248 offset0:0 offset1:16
    ds_read_b128 v[96:99], v247 offset:128
    ds_read_b128 v[104:107], v247 offset:192
    ds_read2_b32 v[112:113], v248 offset0:32 offset1:48
    s_cmp_lt_u32 0, s45
    s_cselect_b32 s14, 12800000, 0
    s_cselect_b32 s18, 12800000, 0
    s_cmp_eq_u32 s63, 0
    s_cbranch_scc1 K2_NOW
    s_waitcnt lgkmcnt(0)
    s_barrier
K2_NOW:
    s_setprio 3
    s_waitcnt lgkmcnt(3)
    v_and_or_b32 v224, v48, v253, v245
    v_and_or_b32 v228, v49, v253, v245
    v_and_or_b32 v4, v32, s55, v244
    v_and_or_b32 v12, v33, s55, v244
    v_and_or_b32 v20, v34, s55, v244
    v_and_or_b32 v28, v35, s55, v244
    v_and_or_b32 v36, v40, s55, v244
    v_and_or_b32 v44, v41, s55, v244
    v_and_or_b32 v52, v42, s55, v244
    v_and_or_b32 v60, v43, s55, v244
    s_mov_b32 exec_hi, 0
    buffer_load_dwordx4 v[224:227], v224, s[16:19], 0 offen sc1
    buffer_load_dwordx4 v[228:231], v228, s[16:19], 0 offen sc1
    s_mov_b64 exec, s[50:51]
    ds_read_b128 v[224:227], v224
    ds_read_b128 v[228:231], v228
    s_mov_b64 exec, -1
    buffer_load_dwordx4 v[0:3], v4, s[12:15], 0 offen sc1
    buffer_load_dwordx4 v[8:11], v12, s[12:15], 0 offen sc1
    buffer_load_dwordx4 v[16:19], v20, s[12:15], 0 offen sc1
    buffer_load_dwordx4 v[24:27], v28, s[12:15], 0 offen sc1
    buffer_load_dwordx4 v[4:7], v4, s[12:15], 0 offen offset:256 sc1
    buffer_load_dwordx4 v[12:15], v12, s[12:15], 0 offen offset:256 sc1
    buffer_load_dwordx4 v[20:23], v20, s[12:15], 0 offen offset:256 sc1
    buffer_load_dwordx4 v[28:31], v28, s[12:15], 0 offen offset:256 sc1
    buffer_load_dwordx4 v[32:35], v36, s[12:15], 0 offen sc1
    buffer_load_dwordx4 v[40:43], v44, s[12:15], 0 offen sc1
    buffer_load_dwordx4 v[48:51], v52, s[12:15], 0 offen sc1
    buffer_load_dwordx4 v[56:59], v60, s[12:15], 0 offen sc1
    buffer_load_dwordx4 v[36:39], v36, s[12:15], 0 offen offset:256 sc1
    buffer_load_dwordx4 v[44:47], v44, s[12:15], 0 offen offset:256 sc1
    buffer_load_dwordx4 v[52:55], v52, s[12:15], 0 offen offset:256 sc1
    buffer_load_dwordx4 v[60:63], v60, s[12:15], 0 offen offset:256 sc1
    s_cmp_eq_u32 s42, 0
    s_cbranch_scc1 K2_NOINIT
    v_and_b32 v114, 63, v250
    v_and_b32 v118, 15, v114
    v_lshrrev_b32 v119, 4, v114
    v_add_u32 v100, s52, v118
    v_xor_b32 v101, v119, v100
    v_and_b32 v101, 15, v101
    v_lshlrev_b32 v101, 4, v101
    v_lshl_add_u32 v100, v100, 8, v101
    v_add_u32 v100, 65536, v100
    v_lshlrev_b32 v114, 4, v114
    v_add_u32 v114, 92160, v114
    ds_read_b128 v[64:67], v100
    v_xor_b32 v101, 64, v100
    ds_read_b128 v[68:71], v101
    v_xor_b32 v101, 128, v100
    ds_read_b128 v[72:75], v101
    v_xor_b32 v101, 192, v100
    ds_read_b128 v[76:79], v101
    ds_read_b128 v[80:83], v114 offset:0
    ds_read_b128 v[84:87], v114 offset:1024
    ds_read_b128 v[88:91], v114 offset:2048
    ds_read_b128 v[92:95], v114 offset:3072
    ds_read_b128 v[108:111], v114 offset:4096
    ds_read_b128 v[120:123], v114 offset:5120
    ds_read_b128 v[124:127], v114 offset:6144
    ds_read_b128 v[232:235], v114 offset:7168
    ds_read_b128 v[236:239], v114 offset:8192
    ds_read_b128 v[160:163], v114 offset:9216
    s_waitcnt lgkmcnt(9)
    v_mfma_f32_16x16x32_bf16 v[192:195], v[64:67], v[80:83], 0
    s_lshl_b32 s37, s33, 12
    ds_read_b128 v[164:167], v114 offset:10240
    s_waitcnt lgkmcnt(9)
    v_mfma_f32_16x16x32_bf16 v[192:195], v[68:71], v[84:87], v[192:195]
    s_add_u32 s37, s37, 25856
    ds_read_b128 v[168:171], v114 offset:11264
    s_waitcnt lgkmcnt(9)
    v_mfma_f32_16x16x32_bf16 v[192:195], v[72:75], v[88:91], v[192:195]
    v_lshl_add_u32 v115, v118, 5, s37
    ds_read_b128 v[80:83], v114 offset:12288
    s_waitcnt lgkmcnt(9)
    v_mfma_f32_16x16x32_bf16 v[192:195], v[76:79], v[92:95], v[192:195]
    v_lshl_add_u32 v115, v119, 3, v115
    ds_read_b128 v[84:87], v114 offset:13312
    s_waitcnt lgkmcnt(9)
    v_mfma_f32_16x16x32_bf16 v[196:199], v[64:67], v[108:111], 0
    s_sub_u32 s37, s37, 157728
    ds_read_b128 v[88:91], v114 offset:14336
    s_waitcnt lgkmcnt(9)
    v_mfma_f32_16x16x32_bf16 v[196:199], v[68:71], v[120:123], v[196:199]
    v_lshlrev_b32 v117, 5, v118
    ds_read_b128 v[92:95], v114 offset:15360
    s_waitcnt lgkmcnt(9)
    v_mfma_f32_16x16x32_bf16 v[196:199], v[72:75], v[124:127], v[196:199]
    v_lshl_add_u32 v117, v119, 4, v117
    ds_read_b128 v[108:111], v114 offset:16384
    s_waitcnt lgkmcnt(9)
    v_mfma_f32_16x16x32_bf16 v[196:199], v[76:79], v[232:235], v[196:199]
    v_add_u32 v117, 157696, v117
    ds_read_b128 v[120:123], v114 offset:17408
    s_waitcnt lgkmcnt(9)
    v_mfma_f32_16x16x32_bf16 v[200:203], v[64:67], v[236:239], 0
    s_mov_b64 exec, s[50:51]
    v_add_u32 v117, s37, v117
    s_mov_b64 exec, -1
    s_nop 1
    ds_read_b128 v[124:127], v114 offset:18432
    s_waitcnt lgkmcnt(9)
    v_mfma_f32_16x16x32_bf16 v[200:203], v[68:71], v[160:163], v[200:203]
    s_mov_b32 s38, 3216550459
    ds_read_b128 v[232:235], v114 offset:19456
    s_waitcnt lgkmcnt(9)
    v_mfma_f32_16x16x32_bf16 v[200:203], v[72:75], v[164:167], v[200:203]
    ds_read_b128 v[236:239], v114 offset:20480
    s_waitcnt lgkmcnt(9)
    v_mfma_f32_16x16x32_bf16 v[200:203], v[76:79], v[168:171], v[200:203]
    ds_read_b128 v[160:163], v114 offset:21504
    s_waitcnt lgkmcnt(9)
    v_mfma_f32_16x16x32_bf16 v[204:207], v[64:67], v[80:83], 0
    ds_read_b128 v[164:167], v114 offset:22528
    s_waitcnt lgkmcnt(9)
    v_mfma_f32_16x16x32_bf16 v[204:207], v[68:71], v[84:87], v[204:207]
    ds_read_b128 v[168:171], v114 offset:23552
    s_waitcnt lgkmcnt(9)
    v_mfma_f32_16x16x32_bf16 v[204:207], v[72:75], v[88:91], v[204:207]
    ds_read_b128 v[80:83], v114 offset:24576
    s_waitcnt lgkmcnt(9)
    v_mfma_f32_16x16x32_bf16 v[204:207], v[76:79], v[92:95], v[204:207]
    ds_read_b128 v[84:87], v114 offset:25600
    s_waitcnt lgkmcnt(9)
    v_mfma_f32_16x16x32_bf16 v[208:211], v[64:67], v[108:111], 0
    ds_read_b128 v[88:91], v114 offset:26624
    s_waitcnt lgkmcnt(9)
    v_mfma_f32_16x16x32_bf16 v[208:211], v[68:71], v[120:123], v[208:211]
    ds_read_b128 v[92:95], v114 offset:27648
    s_waitcnt lgkmcnt(9)
    v_mfma_f32_16x16x32_bf16 v[208:211], v[72:75], v[124:127], v[208:211]
    ds_read_b128 v[108:111], v114 offset:28672
    s_waitcnt lgkmcnt(9)
    v_mfma_f32_16x16x32_bf16 v[208:211], v[76:79], v[232:235], v[208:211]
    ds_read_b128 v[120:123], v114 offset:29696
    s_waitcnt lgkmcnt(9)
    v_mfma_f32_16x16x32_bf16 v[212:215], v[64:67], v[236:239], 0
    ds_read_b128 v[124:127], v114 offset:30720
    s_waitcnt lgkmcnt(9)
    v_mfma_f32_16x16x32_bf16 v[212:215], v[68:71], v[160:163], v[212:215]
    ds_read_b128 v[232:235], v114 offset:31744
    s_waitcnt lgkmcnt(9)
    v_mfma_f32_16x16x32_bf16 v[212:215], v[72:75], v[164:167], v[212:215]
    ds_read_b128 v[236:239], v114 offset:32768
    s_waitcnt lgkmcnt(9)
    v_mfma_f32_16x16x32_bf16 v[212:215], v[76:79], v[168:171], v[212:215]
    ds_read_b128 v[160:163], v114 offset:33792
    s_waitcnt lgkmcnt(9)
    v_mfma_f32_16x16x32_bf16 v[216:219], v[64:67], v[80:83], 0
    ds_read_b128 v[164:167], v114 offset:34816
    s_waitcnt lgkmcnt(9)
    v_mfma_f32_16x16x32_bf16 v[216:219], v[68:71], v[84:87], v[216:219]
    ds_read_b128 v[168:171], v114 offset:35840
    s_waitcnt lgkmcnt(9)
    v_mfma_f32_16x16x32_bf16 v[216:219], v[72:75], v[88:91], v[216:219]
    ds_read_b128 v[80:83], v114 offset:36864
    s_waitcnt lgkmcnt(9)
    v_mfma_f32_16x16x32_bf16 v[216:219], v[76:79], v[92:95], v[216:219]
    ds_read_b128 v[84:87], v114 offset:37888
    s_waitcnt lgkmcnt(9)
    v_mfma_f32_16x16x32_bf16 v[220:223], v[64:67], v[108:111], 0
    ds_read_b128 v[88:91], v114 offset:38912
    s_waitcnt lgkmcnt(9)
    v_mfma_f32_16x16x32_bf16 v[220:223], v[68:71], v[120:123], v[220:223]
    ds_read_b128 v[92:95], v114 offset:39936
    s_waitcnt lgkmcnt(9)
    v_mfma_f32_16x16x32_bf16 v[220:223], v[72:75], v[124:127], v[220:223]
    ds_read_b128 v[108:111], v114 offset:40960
    s_waitcnt lgkmcnt(9)
    v_mfma_f32_16x16x32_bf16 v[220:223], v[76:79], v[232:235], v[220:223]
    ds_read_b128 v[120:123], v114 offset:41984
    s_waitcnt lgkmcnt(9)
    v_mfma_f32_16x16x32_bf16 v[128:131], v[64:67], v[236:239], 0
    ds_read_b128 v[124:127], v114 offset:43008
    s_waitcnt lgkmcnt(9)
    v_mfma_f32_16x16x32_bf16 v[128:131], v[68:71], v[160:163], v[128:131]
    ds_read_b128 v[232:235], v114 offset:44032
    s_waitcnt lgkmcnt(9)
    v_mfma_f32_16x16x32_bf16 v[128:131], v[72:75], v[164:167], v[128:131]
    ds_read_b128 v[236:239], v114 offset:45056
    s_waitcnt lgkmcnt(9)
    v_mfma_f32_16x16x32_bf16 v[128:131], v[76:79], v[168:171], v[128:131]
    ds_read_b128 v[160:163], v114 offset:46080
    s_waitcnt lgkmcnt(9)
    v_mfma_f32_16x16x32_bf16 v[132:135], v[64:67], v[80:83], 0
    v_mul_f32 v192, s38, v192
    v_mul_f32 v193, s38, v193
    ds_read_b128 v[164:167], v114 offset:47104
    s_waitcnt lgkmcnt(9)
    v_mfma_f32_16x16x32_bf16 v[132:135], v[68:71], v[84:87], v[132:135]
    v_mul_f32 v194, s38, v194
    v_mul_f32 v195, s38, v195
    ds_read_b128 v[168:171], v114 offset:48128
    s_waitcnt lgkmcnt(9)
    v_mfma_f32_16x16x32_bf16 v[132:135], v[72:75], v[88:91], v[132:135]
    v_cvt_pk_bf16_f32 v192, v192, v193
    v_cvt_pk_bf16_f32 v193, v194, v195
    ds_write_b64 v115, v[192:193] offset:0
    ds_read_b128 v[80:83], v114 offset:49152
    s_waitcnt lgkmcnt(10)
    v_mfma_f32_16x16x32_bf16 v[132:135], v[76:79], v[92:95], v[132:135]
    v_mul_f32 v196, s38, v196
    v_mul_f32 v197, s38, v197
    ds_read_b128 v[84:87], v114 offset:50176
    s_waitcnt lgkmcnt(10)
    v_mfma_f32_16x16x32_bf16 v[136:139], v[64:67], v[108:111], 0
    v_mul_f32 v198, s38, v198
    v_mul_f32 v199, s38, v199
    ds_read_b128 v[88:91], v114 offset:51200
    s_waitcnt lgkmcnt(10)
    v_mfma_f32_16x16x32_bf16 v[136:139], v[68:71], v[120:123], v[136:139]
    v_cvt_pk_bf16_f32 v196, v196, v197
    v_cvt_pk_bf16_f32 v197, v198, v199
    ds_write_b64 v115, v[196:197] offset:512
    ds_read_b128 v[92:95], v114 offset:52224
    s_waitcnt lgkmcnt(11)
    v_mfma_f32_16x16x32_bf16 v[136:139], v[72:75], v[124:127], v[136:139]
    v_mul_f32 v200, s38, v200
    v_mul_f32 v201, s38, v201
    ds_read_b128 v[108:111], v114 offset:53248
    s_waitcnt lgkmcnt(11)
    v_mfma_f32_16x16x32_bf16 v[136:139], v[76:79], v[232:235], v[136:139]
    v_mul_f32 v202, s38, v202
    v_mul_f32 v203, s38, v203
    ds_read_b128 v[120:123], v114 offset:54272
    s_waitcnt lgkmcnt(11)
    v_mfma_f32_16x16x32_bf16 v[140:143], v[64:67], v[236:239], 0
    v_cvt_pk_bf16_f32 v200, v200, v201
    v_cvt_pk_bf16_f32 v201, v202, v203
    ds_write_b64 v115, v[200:201] offset:1024
    ds_read_b128 v[124:127], v114 offset:55296
    s_waitcnt lgkmcnt(12)
    v_mfma_f32_16x16x32_bf16 v[140:143], v[68:71], v[160:163], v[140:143]
    v_mul_f32 v204, s38, v204
    v_mul_f32 v205, s38, v205
    ds_read_b128 v[232:235], v114 offset:56320
    s_waitcnt lgkmcnt(12)
    v_mfma_f32_16x16x32_bf16 v[140:143], v[72:75], v[164:167], v[140:143]
    v_mul_f32 v206, s38, v206
    v_mul_f32 v207, s38, v207
    ds_read_b128 v[236:239], v114 offset:57344
    s_waitcnt lgkmcnt(12)
    v_mfma_f32_16x16x32_bf16 v[140:143], v[76:79], v[168:171], v[140:143]
    v_cvt_pk_bf16_f32 v204, v204, v205
    v_cvt_pk_bf16_f32 v205, v206, v207
    ds_write_b64 v115, v[204:205] offset:1536
    ds_read_b128 v[160:163], v114 offset:58368
    s_waitcnt lgkmcnt(12)
    v_mfma_f32_16x16x32_bf16 v[144:147], v[64:67], v[80:83], 0
    v_mul_f32 v208, s38, v208
    v_mul_f32 v209, s38, v209
    ds_read_b128 v[164:167], v114 offset:59392
    s_waitcnt lgkmcnt(12)
    v_mfma_f32_16x16x32_bf16 v[144:147], v[68:71], v[84:87], v[144:147]
    v_mul_f32 v210, s38, v210
    v_mul_f32 v211, s38, v211
    ds_read_b128 v[168:171], v114 offset:60416
    s_waitcnt lgkmcnt(12)
    v_mfma_f32_16x16x32_bf16 v[144:147], v[72:75], v[88:91], v[144:147]
    v_cvt_pk_bf16_f32 v208, v208, v209
    v_cvt_pk_bf16_f32 v209, v210, v211
    ds_write_b64 v115, v[208:209] offset:2048
    ds_read_b128 v[80:83], v114 offset:61440
    s_waitcnt lgkmcnt(12)
    v_mfma_f32_16x16x32_bf16 v[144:147], v[76:79], v[92:95], v[144:147]
    v_mul_f32 v212, s38, v212
    v_mul_f32 v213, s38, v213
    ds_read_b128 v[84:87], v114 offset:62464
    s_waitcnt lgkmcnt(12)
    v_mfma_f32_16x16x32_bf16 v[148:151], v[64:67], v[108:111], 0
    v_mul_f32 v214, s38, v214
    v_mul_f32 v215, s38, v215
    ds_read_b128 v[88:91], v114 offset:63488
    s_waitcnt lgkmcnt(12)
    v_mfma_f32_16x16x32_bf16 v[148:151], v[68:71], v[120:123], v[148:151]
    v_cvt_pk_bf16_f32 v212, v212, v213
    v_cvt_pk_bf16_f32 v213, v214, v215
    ds_write_b64 v115, v[212:213] offset:2560
    ds_read_b128 v[92:95], v114 offset:64512
    s_waitcnt lgkmcnt(12)
    v_mfma_f32_16x16x32_bf16 v[148:151], v[72:75], v[124:127], v[148:151]
    v_mul_f32 v216, s38, v216
    v_mul_f32 v217, s38, v217
    s_waitcnt lgkmcnt(11)
    v_mfma_f32_16x16x32_bf16 v[148:151], v[76:79], v[232:235], v[148:151]
    v_mul_f32 v218, s38, v218
    v_mul_f32 v219, s38, v219
    s_waitcnt lgkmcnt(10)
    v_mfma_f32_16x16x32_bf16 v[152:155], v[64:67], v[236:239], 0
    v_cvt_pk_bf16_f32 v216, v216, v217
    v_cvt_pk_bf16_f32 v217, v218, v219
    ds_write_b64 v115, v[216:217] offset:3072
    s_waitcnt lgkmcnt(9)
    v_mfma_f32_16x16x32_bf16 v[152:155], v[68:71], v[160:163], v[152:155]
    v_mul_f32 v220, s38, v220
    v_mul_f32 v221, s38, v221
    s_waitcnt lgkmcnt(8)
    v_mfma_f32_16x16x32_bf16 v[152:155], v[72:75], v[164:167], v[152:155]
    v_mul_f32 v222, s38, v222
    v_mul_f32 v223, s38, v223
    s_waitcnt lgkmcnt(7)
    v_mfma_f32_16x16x32_bf16 v[152:155], v[76:79], v[168:171], v[152:155]
    v_cvt_pk_bf16_f32 v220, v220, v221
    v_cvt_pk_bf16_f32 v221, v222, v223
    ds_write_b64 v115, v[220:221] offset:3584
    s_waitcnt lgkmcnt(6)
    v_mfma_f32_16x16x32_bf16 v[156:159], v[64:67], v[80:83], 0
    s_waitcnt lgkmcnt(5)
    v_mfma_f32_16x16x32_bf16 v[156:159], v[68:71], v[84:87], v[156:159]
    s_waitcnt lgkmcnt(4)
    v_mfma_f32_16x16x32_bf16 v[156:159], v[72:75], v[88:91], v[156:159]
    s_waitcnt lgkmcnt(2)
    v_mfma_f32_16x16x32_bf16 v[156:159], v[76:79], v[92:95], v[156:159]
    s_nop 3
    ds_read_b128 v[160:163], v117 offset:0
    ds_read_b128 v[164:167], v117 offset:512
    ds_read_b128 v[168:171], v117 offset:1024
    ds_read_b128 v[172:175], v117 offset:1536
    ds_read_b128 v[176:179], v117 offset:2048
    ds_read_b128 v[180:183], v117 offset:2560
    ds_read_b128 v[184:187], v117 offset:3072
    ds_read_b128 v[188:191], v117 offset:3584
K2_NOINIT:
    s_setprio 1
    s_mov_b32 s46, 0
    s_cmp_eq_u32 s45, 0
    s_cbranch_scc1 K2_TDONE
    s_waitcnt vmcnt(16) lgkmcnt(0)
    v_mfma_f32_16x16x32_bf16 v[192:195], v[224:227], v[160:163], 0
    v_mfma_f32_16x16x32_bf16 v[196:199], v[224:227], v[164:167], 0
    v_mfma_f32_16x16x32_bf16 v[200:203], v[224:227], v[168:171], 0
    v_mfma_f32_16x16x32_bf16 v[204:207], v[224:227], v[172:175], 0
    v_mov_b32 v208, 0
    v_mov_b32 v209, 0
    v_mov_b32 v210, 0
    v_mov_b32 v211, 0
    v_mov_b32 v212, 0
    v_mov_b32 v213, 0
    v_mov_b32 v214, 0
    v_mov_b32 v215, 0
    v_mov_b32 v216, 0
    v_mov_b32 v217, 0
    v_mov_b32 v218, 0
    v_mov_b32 v219, 0
    v_mov_b32 v220, 0
    v_mov_b32 v221, 0
    v_mov_b32 v222, 0
    v_mov_b32 v223, 0
    s_cmp_eq_u32 s60, 0
    s_cbranch_scc1 K2_LAST0
.p2align 6
K2_LOOP:
    ds_read2_b32 v[240:241], v249 offset0:0 offset1:16
    v_mov_b32 v255, s46
    ds_write2_b32 v254, v255, v255 offset0:0 offset1:16
    ds_read_b32 v255, v254 offset:32
    s_add_u32 s46, s46, 1
    s_waitcnt vmcnt(12)
    v_fma_mix_f32 v208, v0, 1.0, v192 op_sel_hi:[1,0,0]
    v_fma_mix_f32 v212, v8, 1.0, v193 op_sel_hi:[1,0,0]
    v_fma_mix_f32 v216, v16, 1.0, v194 op_sel_hi:[1,0,0]
    v_fma_mix_f32 v220, v24, 1.0, v195 op_sel_hi:[1,0,0]
    v_fma_mix_f32 v209, v1, 1.0, v196 op_sel_hi:[1,0,0]
    v_fma_mix_f32 v213, v9, 1.0, v197 op_sel_hi:[1,0,0]
    v_fma_mix_f32 v217, v17, 1.0, v198 op_sel_hi:[1,0,0]
    v_fma_mix_f32 v221, v25, 1.0, v199 op_sel_hi:[1,0,0]
    v_fma_mix_f32 v210, v2, 1.0, v200 op_sel_hi:[1,0,0]
    v_fma_mix_f32 v214, v10, 1.0, v201 op_sel_hi:[1,0,0]
    v_fma_mix_f32 v218, v18, 1.0, v202 op_sel_hi:[1,0,0]
    v_fma_mix_f32 v222, v26, 1.0, v203 op_sel_hi:[1,0,0]
    v_fma_mix_f32 v211, v3, 1.0, v204 op_sel_hi:[1,0,0]
    v_fma_mix_f32 v215, v11, 1.0, v205 op_sel_hi:[1,0,0]
    v_fma_mix_f32 v219, v19, 1.0, v206 op_sel_hi:[1,0,0]
    v_fma_mix_f32 v223, v27, 1.0, v207 op_sel_hi:[1,0,0]
    s_waitcnt lgkmcnt(0)
    v_readfirstlane_b32 s56, v255
    v_and_or_b32 v242, v241, s54, v246
    v_and_or_b32 v240, v240, s54, v246
    ds_read_b64_tr_b16 v[242:243], v242
    ds_read_b64_tr_b16 v[240:241], v240
    s_add_u32 s56, s56, 1
    s_setprio 1
    s_cmp_gt_u32 s46, s56
    s_cbranch_scc0 K2_PR0
    s_setprio 0
K2_PR0:
    v_and_or_b32 v232, v112, v253, v245
    v_and_or_b32 v236, v113, v253, v245
    v_and_or_b32 v68, v96, s55, v244
    v_and_or_b32 v76, v97, s55, v244
    v_and_or_b32 v84, v98, s55, v244
    v_and_or_b32 v92, v99, s55, v244
    v_and_or_b32 v100, v104, s55, v244
    v_and_or_b32 v108, v105, s55, v244
    v_and_or_b32 v116, v106, s55, v244
    v_and_or_b32 v124, v107, s55, v244
    s_mov_b32 exec_hi, 0
    buffer_load_dwordx4 v[232:235], v232, s[16:19], 0 offen sc1
    buffer_load_dwordx4 v[236:239], v236, s[16:19], 0 offen sc1
    s_mov_b64 exec, s[50:51]
    ds_read_b128 v[232:235], v232
    ds_read_b128 v[236:239], v236
    s_mov_b64 exec, -1
    v_exp_f32 v208, v208
    v_mfma_f32_16x16x32_bf16 v[192:195], v[224:227], v[176:179], 0
    v_exp_f32 v209, v209
    v_mfma_f32_16x16x32_bf16 v[196:199], v[224:227], v[180:183], 0
    v_exp_f32 v210, v210
    v_mfma_f32_16x16x32_bf16 v[200:203], v[224:227], v[184:187], 0
    v_exp_f32 v211, v211
    v_mfma_f32_16x16x32_bf16 v[204:207], v[224:227], v[188:191], 0
    v_exp_f32 v212, v212
    v_exp_f32 v213, v213
    v_exp_f32 v214, v214
    v_exp_f32 v215, v215
    buffer_load_dwordx4 v[64:67], v68, s[12:15], 0 offen sc1
    v_exp_f32 v216, v216
    v_exp_f32 v217, v217
    v_exp_f32 v218, v218
    v_exp_f32 v219, v219
    v_exp_f32 v220, v220
    v_exp_f32 v221, v221
    v_exp_f32 v222, v222
    v_exp_f32 v223, v223
    buffer_load_dwordx4 v[72:75], v76, s[12:15], 0 offen sc1
    v_pk_add_f32 v[208:209], v[208:209], 1.0 op_sel_hi:[1,0]
    v_pk_add_f32 v[210:211], v[210:211], 1.0 op_sel_hi:[1,0]
    v_pk_add_f32 v[212:213], v[212:213], 1.0 op_sel_hi:[1,0]
    v_pk_add_f32 v[214:215], v[214:215], 1.0 op_sel_hi:[1,0]
    v_pk_add_f32 v[216:217], v[216:217], 1.0 op_sel_hi:[1,0]
    v_pk_add_f32 v[218:219], v[218:219], 1.0 op_sel_hi:[1,0]
    v_pk_add_f32 v[220:221], v[220:221], 1.0 op_sel_hi:[1,0]
    v_pk_add_f32 v[222:223], v[222:223], 1.0 op_sel_hi:[1,0]
    v_rcp_f32 v208, v208
    v_rcp_f32 v209, v209
    v_rcp_f32 v210, v210
    v_rcp_f32 v211, v211
    v_rcp_f32 v212, v212
    buffer_load_dwordx4 v[80:83], v84, s[12:15], 0 offen sc1
    v_rcp_f32 v213, v213
    v_rcp_f32 v214, v214
    v_rcp_f32 v215, v215
    v_rcp_f32 v216, v216
    v_rcp_f32 v217, v217
    v_rcp_f32 v218, v218
    v_rcp_f32 v219, v219
    v_rcp_f32 v220, v220
    v_rcp_f32 v221, v221
    buffer_load_dwordx4 v[88:91], v92, s[12:15], 0 offen sc1
    v_rcp_f32 v222, v222
    v_rcp_f32 v223, v223
    v_pk_mul_f32 v[208:209], v[208:209], v[0:1]
    v_pk_mul_f32 v[210:211], v[210:211], v[2:3]
    v_pk_mul_f32 v[212:213], v[212:213], v[8:9]
    v_pk_mul_f32 v[214:215], v[214:215], v[10:11]
    v_pk_mul_f32 v[216:217], v[216:217], v[16:17]
    v_pk_mul_f32 v[218:219], v[218:219], v[18:19]
    v_pk_mul_f32 v[220:221], v[220:221], v[24:25]
    v_pk_mul_f32 v[222:223], v[222:223], v[26:27]
    v_cvt_pk_bf16_f32 v0, v208, v212
    v_cvt_pk_bf16_f32 v1, v216, v220
    v_cvt_pk_bf16_f32 v8, v209, v213
    v_cvt_pk_bf16_f32 v9, v217, v221
    v_cvt_pk_bf16_f32 v16, v210, v214
    v_cvt_pk_bf16_f32 v17, v218, v222
    v_cvt_pk_bf16_f32 v24, v211, v215
    v_cvt_pk_bf16_f32 v25, v219, v223
    s_waitcnt vmcnt(14)
    v_fma_mix_f32 v208, v4, 1.0, v192 op_sel_hi:[1,0,0]
    v_fma_mix_f32 v212, v12, 1.0, v193 op_sel_hi:[1,0,0]
    v_fma_mix_f32 v216, v20, 1.0, v194 op_sel_hi:[1,0,0]
    v_fma_mix_f32 v220, v28, 1.0, v195 op_sel_hi:[1,0,0]
    v_fma_mix_f32 v209, v5, 1.0, v196 op_sel_hi:[1,0,0]
    v_fma_mix_f32 v213, v13, 1.0, v197 op_sel_hi:[1,0,0]
    v_fma_mix_f32 v217, v21, 1.0, v198 op_sel_hi:[1,0,0]
    v_fma_mix_f32 v221, v29, 1.0, v199 op_sel_hi:[1,0,0]
    v_fma_mix_f32 v210, v6, 1.0, v200 op_sel_hi:[1,0,0]
    v_fma_mix_f32 v214, v14, 1.0, v201 op_sel_hi:[1,0,0]
    v_fma_mix_f32 v218, v22, 1.0, v202 op_sel_hi:[1,0,0]
    v_fma_mix_f32 v222, v30, 1.0, v203 op_sel_hi:[1,0,0]
    v_fma_mix_f32 v211, v7, 1.0, v204 op_sel_hi:[1,0,0]
    v_fma_mix_f32 v215, v15, 1.0, v205 op_sel_hi:[1,0,0]
    v_fma_mix_f32 v219, v23, 1.0, v206 op_sel_hi:[1,0,0]
    v_fma_mix_f32 v223, v31, 1.0, v207 op_sel_hi:[1,0,0]
    v_exp_f32 v208, v208
    v_mfma_f32_16x16x32_bf16 v[192:195], v[228:231], v[160:163], 0
    v_exp_f32 v209, v209
    v_mfma_f32_16x16x32_bf16 v[196:199], v[228:231], v[164:167], 0
    v_exp_f32 v210, v210
    v_mfma_f32_16x16x32_bf16 v[200:203], v[228:231], v[168:171], 0
    v_exp_f32 v211, v211
    v_mfma_f32_16x16x32_bf16 v[204:207], v[228:231], v[172:175], 0
    v_exp_f32 v212, v212
    v_exp_f32 v213, v213
    v_exp_f32 v214, v214
    v_exp_f32 v215, v215
    buffer_load_dwordx4 v[68:71], v68, s[12:15], 0 offen offset:256 sc1
    v_exp_f32 v216, v216
    v_exp_f32 v217, v217
    v_exp_f32 v218, v218
    v_exp_f32 v219, v219
    v_exp_f32 v220, v220
    v_exp_f32 v221, v221
    v_exp_f32 v222, v222
    v_exp_f32 v223, v223
    buffer_load_dwordx4 v[76:79], v76, s[12:15], 0 offen offset:256 sc1
    v_pk_add_f32 v[208:209], v[208:209], 1.0 op_sel_hi:[1,0]
    v_pk_add_f32 v[210:211], v[210:211], 1.0 op_sel_hi:[1,0]
    v_pk_add_f32 v[212:213], v[212:213], 1.0 op_sel_hi:[1,0]
    v_pk_add_f32 v[214:215], v[214:215], 1.0 op_sel_hi:[1,0]
    v_pk_add_f32 v[216:217], v[216:217], 1.0 op_sel_hi:[1,0]
    v_pk_add_f32 v[218:219], v[218:219], 1.0 op_sel_hi:[1,0]
    v_pk_add_f32 v[220:221], v[220:221], 1.0 op_sel_hi:[1,0]
    v_pk_add_f32 v[222:223], v[222:223], 1.0 op_sel_hi:[1,0]
    v_rcp_f32 v208, v208
    v_rcp_f32 v209, v209
    v_rcp_f32 v210, v210
    v_rcp_f32 v211, v211
    v_rcp_f32 v212, v212
    buffer_load_dwordx4 v[84:87], v84, s[12:15], 0 offen offset:256 sc1
    v_rcp_f32 v213, v213
    v_rcp_f32 v214, v214
    v_rcp_f32 v215, v215
    v_rcp_f32 v216, v216
    v_rcp_f32 v217, v217
    v_rcp_f32 v218, v218
    v_rcp_f32 v219, v219
    v_rcp_f32 v220, v220
    v_rcp_f32 v221, v221
    buffer_load_dwordx4 v[92:95], v92, s[12:15], 0 offen offset:256 sc1
    v_rcp_f32 v222, v222
    v_rcp_f32 v223, v223
    v_pk_mul_f32 v[208:209], v[208:209], v[4:5]
    v_pk_mul_f32 v[210:211], v[210:211], v[6:7]
    v_pk_mul_f32 v[212:213], v[212:213], v[12:13]
    v_pk_mul_f32 v[214:215], v[214:215], v[14:15]
    v_pk_mul_f32 v[216:217], v[216:217], v[20:21]
    v_pk_mul_f32 v[218:219], v[218:219], v[22:23]
    v_pk_mul_f32 v[220:221], v[220:221], v[28:29]
    v_pk_mul_f32 v[222:223], v[222:223], v[30:31]
    v_cvt_pk_bf16_f32 v4, v208, v212
    v_cvt_pk_bf16_f32 v5, v216, v220
    v_cvt_pk_bf16_f32 v12, v209, v213
    v_cvt_pk_bf16_f32 v13, v217, v221
    v_cvt_pk_bf16_f32 v20, v210, v214
    v_cvt_pk_bf16_f32 v21, v218, v222
    v_cvt_pk_bf16_f32 v28, v211, v215
    v_cvt_pk_bf16_f32 v29, v219, v223
    s_waitcnt vmcnt(14)
    v_fma_mix_f32 v208, v32, 1.0, v192 op_sel_hi:[1,0,0]
    v_fma_mix_f32 v212, v40, 1.0, v193 op_sel_hi:[1,0,0]
    v_fma_mix_f32 v216, v48, 1.0, v194 op_sel_hi:[1,0,0]
    v_fma_mix_f32 v220, v56, 1.0, v195 op_sel_hi:[1,0,0]
    v_fma_mix_f32 v209, v33, 1.0, v196 op_sel_hi:[1,0,0]
    v_fma_mix_f32 v213, v41, 1.0, v197 op_sel_hi:[1,0,0]
    v_fma_mix_f32 v217, v49, 1.0, v198 op_sel_hi:[1,0,0]
    v_fma_mix_f32 v221, v57, 1.0, v199 op_sel_hi:[1,0,0]
    v_fma_mix_f32 v210, v34, 1.0, v200 op_sel_hi:[1,0,0]
    v_fma_mix_f32 v214, v42, 1.0, v201 op_sel_hi:[1,0,0]
    v_fma_mix_f32 v218, v50, 1.0, v202 op_sel_hi:[1,0,0]
    v_fma_mix_f32 v222, v58, 1.0, v203 op_sel_hi:[1,0,0]
    v_fma_mix_f32 v211, v35, 1.0, v204 op_sel_hi:[1,0,0]
    v_fma_mix_f32 v215, v43, 1.0, v205 op_sel_hi:[1,0,0]
    v_fma_mix_f32 v219, v51, 1.0, v206 op_sel_hi:[1,0,0]
    v_fma_mix_f32 v223, v59, 1.0, v207 op_sel_hi:[1,0,0]
    v_exp_f32 v208, v208
    v_mfma_f32_16x16x32_bf16 v[192:195], v[228:231], v[176:179], 0
    v_exp_f32 v209, v209
    v_mfma_f32_16x16x32_bf16 v[196:199], v[228:231], v[180:183], 0
    v_exp_f32 v210, v210
    v_mfma_f32_16x16x32_bf16 v[200:203], v[228:231], v[184:187], 0
    v_exp_f32 v211, v211
    v_mfma_f32_16x16x32_bf16 v[204:207], v[228:231], v[188:191], 0
    v_exp_f32 v212, v212
    v_exp_f32 v213, v213
    v_exp_f32 v214, v214
    v_exp_f32 v215, v215
    buffer_load_dwordx4 v[96:99], v100, s[12:15], 0 offen sc1
    v_exp_f32 v216, v216
    v_exp_f32 v217, v217
    v_exp_f32 v218, v218
    v_exp_f32 v219, v219
    v_exp_f32 v220, v220
    v_exp_f32 v221, v221
    v_exp_f32 v222, v222
    v_exp_f32 v223, v223
    buffer_load_dwordx4 v[104:107], v108, s[12:15], 0 offen sc1
    v_pk_add_f32 v[208:209], v[208:209], 1.0 op_sel_hi:[1,0]
    v_pk_add_f32 v[210:211], v[210:211], 1.0 op_sel_hi:[1,0]
    v_pk_add_f32 v[212:213], v[212:213], 1.0 op_sel_hi:[1,0]
    v_pk_add_f32 v[214:215], v[214:215], 1.0 op_sel_hi:[1,0]
    v_pk_add_f32 v[216:217], v[216:217], 1.0 op_sel_hi:[1,0]
    v_pk_add_f32 v[218:219], v[218:219], 1.0 op_sel_hi:[1,0]
    v_pk_add_f32 v[220:221], v[220:221], 1.0 op_sel_hi:[1,0]
    v_pk_add_f32 v[222:223], v[222:223], 1.0 op_sel_hi:[1,0]
    v_rcp_f32 v208, v208
    v_rcp_f32 v209, v209
    v_rcp_f32 v210, v210
    v_rcp_f32 v211, v211
    v_rcp_f32 v212, v212
    buffer_load_dwordx4 v[112:115], v116, s[12:15], 0 offen sc1
    v_rcp_f32 v213, v213
    v_rcp_f32 v214, v214
    v_rcp_f32 v215, v215
    v_rcp_f32 v216, v216
    v_rcp_f32 v217, v217
    v_rcp_f32 v218, v218
    v_rcp_f32 v219, v219
    v_rcp_f32 v220, v220
    v_rcp_f32 v221, v221
    buffer_load_dwordx4 v[120:123], v124, s[12:15], 0 offen sc1
    v_rcp_f32 v222, v222
    v_rcp_f32 v223, v223
    v_pk_mul_f32 v[208:209], v[208:209], v[32:33]
    v_pk_mul_f32 v[210:211], v[210:211], v[34:35]
    v_pk_mul_f32 v[212:213], v[212:213], v[40:41]
    v_pk_mul_f32 v[214:215], v[214:215], v[42:43]
    v_pk_mul_f32 v[216:217], v[216:217], v[48:49]
    v_pk_mul_f32 v[218:219], v[218:219], v[50:51]
    v_pk_mul_f32 v[220:221], v[220:221], v[56:57]
    v_pk_mul_f32 v[222:223], v[222:223], v[58:59]
    ds_read_b128 v[32:35], v247 offset:256
    ds_read_b128 v[40:43], v247 offset:320
    ds_read2_b32 v[48:49], v248 offset0:64 offset1:80
    v_cvt_pk_bf16_f32 v2, v208, v212
    v_cvt_pk_bf16_f32 v3, v216, v220
    v_cvt_pk_bf16_f32 v10, v209, v213
    v_cvt_pk_bf16_f32 v11, v217, v221
    v_cvt_pk_bf16_f32 v18, v210, v214
    v_cvt_pk_bf16_f32 v19, v218, v222
    v_cvt_pk_bf16_f32 v26, v211, v215
    v_cvt_pk_bf16_f32 v27, v219, v223
    s_waitcnt lgkmcnt(3)
    s_waitcnt vmcnt(14)
    v_fma_mix_f32 v208, v36, 1.0, v192 op_sel_hi:[1,0,0]
    v_fma_mix_f32 v212, v44, 1.0, v193 op_sel_hi:[1,0,0]
    v_mfma_f32_16x16x32_bf16 v[128:131], v[240:243], v[0:3], v[128:131]
    v_fma_mix_f32 v216, v52, 1.0, v194 op_sel_hi:[1,0,0]
    v_fma_mix_f32 v220, v60, 1.0, v195 op_sel_hi:[1,0,0]
    v_mfma_f32_16x16x32_bf16 v[132:135], v[240:243], v[8:11], v[132:135]
    v_fma_mix_f32 v209, v37, 1.0, v196 op_sel_hi:[1,0,0]
    v_fma_mix_f32 v213, v45, 1.0, v197 op_sel_hi:[1,0,0]
    v_mfma_f32_16x16x32_bf16 v[136:139], v[240:243], v[16:19], v[136:139]
    v_fma_mix_f32 v217, v53, 1.0, v198 op_sel_hi:[1,0,0]
    v_fma_mix_f32 v221, v61, 1.0, v199 op_sel_hi:[1,0,0]
    v_mfma_f32_16x16x32_bf16 v[140:143], v[240:243], v[24:27], v[140:143]
    v_fma_mix_f32 v210, v38, 1.0, v200 op_sel_hi:[1,0,0]
    v_fma_mix_f32 v214, v46, 1.0, v201 op_sel_hi:[1,0,0]
    v_fma_mix_f32 v218, v54, 1.0, v202 op_sel_hi:[1,0,0]
    v_fma_mix_f32 v222, v62, 1.0, v203 op_sel_hi:[1,0,0]
    v_fma_mix_f32 v211, v39, 1.0, v204 op_sel_hi:[1,0,0]
    v_fma_mix_f32 v215, v47, 1.0, v205 op_sel_hi:[1,0,0]
    v_fma_mix_f32 v219, v55, 1.0, v206 op_sel_hi:[1,0,0]
    v_fma_mix_f32 v223, v63, 1.0, v207 op_sel_hi:[1,0,0]
    s_waitcnt vmcnt(12) lgkmcnt(3)
    v_exp_f32 v208, v208
    v_mfma_f32_16x16x32_bf16 v[192:195], v[232:235], v[160:163], 0
    v_exp_f32 v209, v209
    v_mfma_f32_16x16x32_bf16 v[196:199], v[232:235], v[164:167], 0
    v_exp_f32 v210, v210
    v_mfma_f32_16x16x32_bf16 v[200:203], v[232:235], v[168:171], 0
    v_exp_f32 v211, v211
    v_mfma_f32_16x16x32_bf16 v[204:207], v[232:235], v[172:175], 0
    v_exp_f32 v212, v212
    v_exp_f32 v213, v213
    v_exp_f32 v214, v214
    v_exp_f32 v215, v215
    buffer_load_dwordx4 v[100:103], v100, s[12:15], 0 offen offset:256 sc1
    v_exp_f32 v216, v216
    v_exp_f32 v217, v217
    v_exp_f32 v218, v218
    v_exp_f32 v219, v219
    v_exp_f32 v220, v220
    v_exp_f32 v221, v221
    v_exp_f32 v222, v222
    v_exp_f32 v223, v223
    buffer_load_dwordx4 v[108:111], v108, s[12:15], 0 offen offset:256 sc1
    v_pk_add_f32 v[208:209], v[208:209], 1.0 op_sel_hi:[1,0]
    v_pk_add_f32 v[210:211], v[210:211], 1.0 op_sel_hi:[1,0]
    v_pk_add_f32 v[212:213], v[212:213], 1.0 op_sel_hi:[1,0]
    v_pk_add_f32 v[214:215], v[214:215], 1.0 op_sel_hi:[1,0]
    v_pk_add_f32 v[216:217], v[216:217], 1.0 op_sel_hi:[1,0]
    v_pk_add_f32 v[218:219], v[218:219], 1.0 op_sel_hi:[1,0]
    v_pk_add_f32 v[220:221], v[220:221], 1.0 op_sel_hi:[1,0]
    v_pk_add_f32 v[222:223], v[222:223], 1.0 op_sel_hi:[1,0]
    v_rcp_f32 v208, v208
    v_rcp_f32 v209, v209
    v_rcp_f32 v210, v210
    v_rcp_f32 v211, v211
    v_rcp_f32 v212, v212
    buffer_load_dwordx4 v[116:119], v116, s[12:15], 0 offen offset:256 sc1
    v_rcp_f32 v213, v213
    v_rcp_f32 v214, v214
    v_rcp_f32 v215, v215
    v_rcp_f32 v216, v216
    v_rcp_f32 v217, v217
    v_rcp_f32 v218, v218
    v_rcp_f32 v219, v219
    v_rcp_f32 v220, v220
    v_rcp_f32 v221, v221
    buffer_load_dwordx4 v[124:127], v124, s[12:15], 0 offen offset:256 sc1
    v_rcp_f32 v222, v222
    v_rcp_f32 v223, v223
    v_pk_mul_f32 v[208:209], v[208:209], v[36:37]
    v_pk_mul_f32 v[210:211], v[210:211], v[38:39]
    v_pk_mul_f32 v[212:213], v[212:213], v[44:45]
    v_pk_mul_f32 v[214:215], v[214:215], v[46:47]
    v_pk_mul_f32 v[216:217], v[216:217], v[52:53]
    v_pk_mul_f32 v[218:219], v[218:219], v[54:55]
    v_pk_mul_f32 v[220:221], v[220:221], v[60:61]
    v_pk_mul_f32 v[222:223], v[222:223], v[62:63]
    v_cvt_pk_bf16_f32 v6, v208, v212
    v_cvt_pk_bf16_f32 v7, v216, v220
    v_cvt_pk_bf16_f32 v14, v209, v213
    v_cvt_pk_bf16_f32 v15, v217, v221
    v_cvt_pk_bf16_f32 v22, v210, v214
    v_cvt_pk_bf16_f32 v23, v218, v222
    v_cvt_pk_bf16_f32 v30, v211, v215
    v_cvt_pk_bf16_f32 v31, v219, v223
    s_cmp_eq_u32 s46, s60
    s_nop 0
    v_mfma_f32_16x16x32_bf16 v[144:147], v[240:243], v[4:7], v[144:147]
    v_mfma_f32_16x16x32_bf16 v[148:151], v[240:243], v[12:15], v[148:151]
    v_mfma_f32_16x16x32_bf16 v[152:155], v[240:243], v[20:23], v[152:155]
    v_mfma_f32_16x16x32_bf16 v[156:159], v[240:243], v[28:31], v[156:159]
    s_cbranch_scc1 K2_LAST1
    ds_read2_b32 v[240:241], v249 offset0:32 offset1:48
    v_mov_b32 v255, s46
    ds_write2_b32 v254, v255, v255 offset0:0 offset1:16
    ds_read_b32 v255, v254 offset:32
    s_add_u32 s46, s46, 1
    s_waitcnt vmcnt(12)
    v_fma_mix_f32 v208, v64, 1.0, v192 op_sel_hi:[1,0,0]
    v_fma_mix_f32 v212, v72, 1.0, v193 op_sel_hi:[1,0,0]
    v_fma_mix_f32 v216, v80, 1.0, v194 op_sel_hi:[1,0,0]
    v_fma_mix_f32 v220, v88, 1.0, v195 op_sel_hi:[1,0,0]
    v_fma_mix_f32 v209, v65, 1.0, v196 op_sel_hi:[1,0,0]
    v_fma_mix_f32 v213, v73, 1.0, v197 op_sel_hi:[1,0,0]
    v_fma_mix_f32 v217, v81, 1.0, v198 op_sel_hi:[1,0,0]
    v_fma_mix_f32 v221, v89, 1.0, v199 op_sel_hi:[1,0,0]
    v_fma_mix_f32 v210, v66, 1.0, v200 op_sel_hi:[1,0,0]
    v_fma_mix_f32 v214, v74, 1.0, v201 op_sel_hi:[1,0,0]
    v_fma_mix_f32 v218, v82, 1.0, v202 op_sel_hi:[1,0,0]
    v_fma_mix_f32 v222, v90, 1.0, v203 op_sel_hi:[1,0,0]
    v_fma_mix_f32 v211, v67, 1.0, v204 op_sel_hi:[1,0,0]
    v_fma_mix_f32 v215, v75, 1.0, v205 op_sel_hi:[1,0,0]
    v_fma_mix_f32 v219, v83, 1.0, v206 op_sel_hi:[1,0,0]
    v_fma_mix_f32 v223, v91, 1.0, v207 op_sel_hi:[1,0,0]
    s_waitcnt lgkmcnt(0)
    v_readfirstlane_b32 s56, v255
    v_and_or_b32 v242, v241, s54, v246
    v_and_or_b32 v240, v240, s54, v246
    ds_read_b64_tr_b16 v[242:243], v242
    ds_read_b64_tr_b16 v[240:241], v240
    s_add_u32 s56, s56, 1
    s_setprio 1
    s_cmp_gt_u32 s46, s56
    s_cbranch_scc0 K2_PR1
    s_setprio 0
K2_PR1:
    v_and_or_b32 v224, v48, v253, v245
    v_and_or_b32 v228, v49, v253, v245
    v_and_or_b32 v4, v32, s55, v244
    v_and_or_b32 v12, v33, s55, v244
    v_and_or_b32 v20, v34, s55, v244
    v_and_or_b32 v28, v35, s55, v244
    v_and_or_b32 v36, v40, s55, v244
    v_and_or_b32 v44, v41, s55, v244
    v_and_or_b32 v52, v42, s55, v244
    v_and_or_b32 v60, v43, s55, v244
    s_mov_b32 exec_hi, 0
    buffer_load_dwordx4 v[224:227], v224, s[16:19], 0 offen sc1
    buffer_load_dwordx4 v[228:231], v228, s[16:19], 0 offen sc1
    s_mov_b64 exec, s[50:51]
    ds_read_b128 v[224:227], v224
    ds_read_b128 v[228:231], v228
    s_mov_b64 exec, -1
    v_exp_f32 v208, v208
    v_mfma_f32_16x16x32_bf16 v[192:195], v[232:235], v[176:179], 0
    v_exp_f32 v209, v209
    v_mfma_f32_16x16x32_bf16 v[196:199], v[232:235], v[180:183], 0
    v_exp_f32 v210, v210
    v_mfma_f32_16x16x32_bf16 v[200:203], v[232:235], v[184:187], 0
    v_exp_f32 v211, v211
    v_mfma_f32_16x16x32_bf16 v[204:207], v[232:235], v[188:191], 0
    v_exp_f32 v212, v212
    v_exp_f32 v213, v213
    v_exp_f32 v214, v214
    v_exp_f32 v215, v215
    buffer_load_dwordx4 v[0:3], v4, s[12:15], 0 offen sc1
    v_exp_f32 v216, v216
    v_exp_f32 v217, v217
    v_exp_f32 v218, v218
    v_exp_f32 v219, v219
    v_exp_f32 v220, v220
    v_exp_f32 v221, v221
    v_exp_f32 v222, v222
    v_exp_f32 v223, v223
    buffer_load_dwordx4 v[8:11], v12, s[12:15], 0 offen sc1
    v_pk_add_f32 v[208:209], v[208:209], 1.0 op_sel_hi:[1,0]
    v_pk_add_f32 v[210:211], v[210:211], 1.0 op_sel_hi:[1,0]
    v_pk_add_f32 v[212:213], v[212:213], 1.0 op_sel_hi:[1,0]
    v_pk_add_f32 v[214:215], v[214:215], 1.0 op_sel_hi:[1,0]
    v_pk_add_f32 v[216:217], v[216:217], 1.0 op_sel_hi:[1,0]
    v_pk_add_f32 v[218:219], v[218:219], 1.0 op_sel_hi:[1,0]
    v_pk_add_f32 v[220:221], v[220:221], 1.0 op_sel_hi:[1,0]
    v_pk_add_f32 v[222:223], v[222:223], 1.0 op_sel_hi:[1,0]
    v_rcp_f32 v208, v208
    v_rcp_f32 v209, v209
    v_rcp_f32 v210, v210
    v_rcp_f32 v211, v211
    v_rcp_f32 v212, v212
    buffer_load_dwordx4 v[16:19], v20, s[12:15], 0 offen sc1
    v_rcp_f32 v213, v213
    v_rcp_f32 v214, v214
    v_rcp_f32 v215, v215
    v_rcp_f32 v216, v216
    v_rcp_f32 v217, v217
    v_rcp_f32 v218, v218
    v_rcp_f32 v219, v219
    v_rcp_f32 v220, v220
    v_rcp_f32 v221, v221
    buffer_load_dwordx4 v[24:27], v28, s[12:15], 0 offen sc1
    v_rcp_f32 v222, v222
    v_rcp_f32 v223, v223
    v_pk_mul_f32 v[208:209], v[208:209], v[64:65]
    v_pk_mul_f32 v[210:211], v[210:211], v[66:67]
    v_pk_mul_f32 v[212:213], v[212:213], v[72:73]
    v_pk_mul_f32 v[214:215], v[214:215], v[74:75]
    v_pk_mul_f32 v[216:217], v[216:217], v[80:81]
    v_pk_mul_f32 v[218:219], v[218:219], v[82:83]
    v_pk_mul_f32 v[220:221], v[220:221], v[88:89]
    v_pk_mul_f32 v[222:223], v[222:223], v[90:91]
    v_cvt_pk_bf16_f32 v64, v208, v212
    v_cvt_pk_bf16_f32 v65, v216, v220
    v_cvt_pk_bf16_f32 v72, v209, v213
    v_cvt_pk_bf16_f32 v73, v217, v221
    v_cvt_pk_bf16_f32 v80, v210, v214
    v_cvt_pk_bf16_f32 v81, v218, v222
    v_cvt_pk_bf16_f32 v88, v211, v215
    v_cvt_pk_bf16_f32 v89, v219, v223
    s_waitcnt vmcnt(14)
    v_fma_mix_f32 v208, v68, 1.0, v192 op_sel_hi:[1,0,0]
    v_fma_mix_f32 v212, v76, 1.0, v193 op_sel_hi:[1,0,0]
    v_fma_mix_f32 v216, v84, 1.0, v194 op_sel_hi:[1,0,0]
    v_fma_mix_f32 v220, v92, 1.0, v195 op_sel_hi:[1,0,0]
    v_fma_mix_f32 v209, v69, 1.0, v196 op_sel_hi:[1,0,0]
    v_fma_mix_f32 v213, v77, 1.0, v197 op_sel_hi:[1,0,0]
    v_fma_mix_f32 v217, v85, 1.0, v198 op_sel_hi:[1,0,0]
    v_fma_mix_f32 v221, v93, 1.0, v199 op_sel_hi:[1,0,0]
    v_fma_mix_f32 v210, v70, 1.0, v200 op_sel_hi:[1,0,0]
    v_fma_mix_f32 v214, v78, 1.0, v201 op_sel_hi:[1,0,0]
    v_fma_mix_f32 v218, v86, 1.0, v202 op_sel_hi:[1,0,0]
    v_fma_mix_f32 v222, v94, 1.0, v203 op_sel_hi:[1,0,0]
    v_fma_mix_f32 v211, v71, 1.0, v204 op_sel_hi:[1,0,0]
    v_fma_mix_f32 v215, v79, 1.0, v205 op_sel_hi:[1,0,0]
    v_fma_mix_f32 v219, v87, 1.0, v206 op_sel_hi:[1,0,0]
    v_fma_mix_f32 v223, v95, 1.0, v207 op_sel_hi:[1,0,0]
    v_exp_f32 v208, v208
    v_mfma_f32_16x16x32_bf16 v[192:195], v[236:239], v[160:163], 0
    v_exp_f32 v209, v209
    v_mfma_f32_16x16x32_bf16 v[196:199], v[236:239], v[164:167], 0
    v_exp_f32 v210, v210
    v_mfma_f32_16x16x32_bf16 v[200:203], v[236:239], v[168:171], 0
    v_exp_f32 v211, v211
    v_mfma_f32_16x16x32_bf16 v[204:207], v[236:239], v[172:175], 0
    v_exp_f32 v212, v212
    v_exp_f32 v213, v213
    v_exp_f32 v214, v214
    v_exp_f32 v215, v215
    buffer_load_dwordx4 v[4:7], v4, s[12:15], 0 offen offset:256 sc1
    v_exp_f32 v216, v216
    v_exp_f32 v217, v217
    v_exp_f32 v218, v218
    v_exp_f32 v219, v219
    v_exp_f32 v220, v220
    v_exp_f32 v221, v221
    v_exp_f32 v222, v222
    v_exp_f32 v223, v223
    buffer_load_dwordx4 v[12:15], v12, s[12:15], 0 offen offset:256 sc1
    v_pk_add_f32 v[208:209], v[208:209], 1.0 op_sel_hi:[1,0]
    v_pk_add_f32 v[210:211], v[210:211], 1.0 op_sel_hi:[1,0]
    v_pk_add_f32 v[212:213], v[212:213], 1.0 op_sel_hi:[1,0]
    v_pk_add_f32 v[214:215], v[214:215], 1.0 op_sel_hi:[1,0]
    v_pk_add_f32 v[216:217], v[216:217], 1.0 op_sel_hi:[1,0]
    v_pk_add_f32 v[218:219], v[218:219], 1.0 op_sel_hi:[1,0]
    v_pk_add_f32 v[220:221], v[220:221], 1.0 op_sel_hi:[1,0]
    v_pk_add_f32 v[222:223], v[222:223], 1.0 op_sel_hi:[1,0]
    v_rcp_f32 v208, v208
    v_rcp_f32 v209, v209
    v_rcp_f32 v210, v210
    v_rcp_f32 v211, v211
    v_rcp_f32 v212, v212
    buffer_load_dwordx4 v[20:23], v20, s[12:15], 0 offen offset:256 sc1
    v_rcp_f32 v213, v213
    v_rcp_f32 v214, v214
    v_rcp_f32 v215, v215
    v_rcp_f32 v216, v216
    v_rcp_f32 v217, v217
    v_rcp_f32 v218, v218
    v_rcp_f32 v219, v219
    v_rcp_f32 v220, v220
    v_rcp_f32 v221, v221
    buffer_load_dwordx4 v[28:31], v28, s[12:15], 0 offen offset:256 sc1
    v_rcp_f32 v222, v222
    v_rcp_f32 v223, v223
    v_pk_mul_f32 v[208:209], v[208:209], v[68:69]
    v_pk_mul_f32 v[210:211], v[210:211], v[70:71]
    v_pk_mul_f32 v[212:213], v[212:213], v[76:77]
    v_pk_mul_f32 v[214:215], v[214:215], v[78:79]
    v_pk_mul_f32 v[216:217], v[216:217], v[84:85]
    v_pk_mul_f32 v[218:219], v[218:219], v[86:87]
    v_pk_mul_f32 v[220:221], v[220:221], v[92:93]
    v_pk_mul_f32 v[222:223], v[222:223], v[94:95]
    v_cvt_pk_bf16_f32 v68, v208, v212
    v_cvt_pk_bf16_f32 v69, v216, v220
    v_cvt_pk_bf16_f32 v76, v209, v213
    v_cvt_pk_bf16_f32 v77, v217, v221
    v_cvt_pk_bf16_f32 v84, v210, v214
    v_cvt_pk_bf16_f32 v85, v218, v222
    v_cvt_pk_bf16_f32 v92, v211, v215
    v_cvt_pk_bf16_f32 v93, v219, v223
    s_waitcnt vmcnt(14)
    v_fma_mix_f32 v208, v96, 1.0, v192 op_sel_hi:[1,0,0]
    v_fma_mix_f32 v212, v104, 1.0, v193 op_sel_hi:[1,0,0]
    v_fma_mix_f32 v216, v112, 1.0, v194 op_sel_hi:[1,0,0]
    v_fma_mix_f32 v220, v120, 1.0, v195 op_sel_hi:[1,0,0]
    v_fma_mix_f32 v209, v97, 1.0, v196 op_sel_hi:[1,0,0]
    v_fma_mix_f32 v213, v105, 1.0, v197 op_sel_hi:[1,0,0]
    v_fma_mix_f32 v217, v113, 1.0, v198 op_sel_hi:[1,0,0]
    v_fma_mix_f32 v221, v121, 1.0, v199 op_sel_hi:[1,0,0]
    v_fma_mix_f32 v210, v98, 1.0, v200 op_sel_hi:[1,0,0]
    v_fma_mix_f32 v214, v106, 1.0, v201 op_sel_hi:[1,0,0]
    v_fma_mix_f32 v218, v114, 1.0, v202 op_sel_hi:[1,0,0]
    v_fma_mix_f32 v222, v122, 1.0, v203 op_sel_hi:[1,0,0]
    v_fma_mix_f32 v211, v99, 1.0, v204 op_sel_hi:[1,0,0]
    v_fma_mix_f32 v215, v107, 1.0, v205 op_sel_hi:[1,0,0]
    v_fma_mix_f32 v219, v115, 1.0, v206 op_sel_hi:[1,0,0]
    v_fma_mix_f32 v223, v123, 1.0, v207 op_sel_hi:[1,0,0]
    v_exp_f32 v208, v208
    v_mfma_f32_16x16x32_bf16 v[192:195], v[236:239], v[176:179], 0
    v_exp_f32 v209, v209
    v_mfma_f32_16x16x32_bf16 v[196:199], v[236:239], v[180:183], 0
    v_exp_f32 v210, v210
    v_mfma_f32_16x16x32_bf16 v[200:203], v[236:239], v[184:187], 0
    v_exp_f32 v211, v211
    v_mfma_f32_16x16x32_bf16 v[204:207], v[236:239], v[188:191], 0
    v_exp_f32 v212, v212
    v_exp_f32 v213, v213
    v_exp_f32 v214, v214
    v_exp_f32 v215, v215
    buffer_load_dwordx4 v[32:35], v36, s[12:15], 0 offen sc1
    v_exp_f32 v216, v216
    v_exp_f32 v217, v217
    v_exp_f32 v218, v218
    v_exp_f32 v219, v219
    v_exp_f32 v220, v220
    v_exp_f32 v221, v221
    v_exp_f32 v222, v222
    v_exp_f32 v223, v223
    buffer_load_dwordx4 v[40:43], v44, s[12:15], 0 offen sc1
    v_pk_add_f32 v[208:209], v[208:209], 1.0 op_sel_hi:[1,0]
    v_pk_add_f32 v[210:211], v[210:211], 1.0 op_sel_hi:[1,0]
    v_pk_add_f32 v[212:213], v[212:213], 1.0 op_sel_hi:[1,0]
    v_pk_add_f32 v[214:215], v[214:215], 1.0 op_sel_hi:[1,0]
    v_pk_add_f32 v[216:217], v[216:217], 1.0 op_sel_hi:[1,0]
    v_pk_add_f32 v[218:219], v[218:219], 1.0 op_sel_hi:[1,0]
    v_pk_add_f32 v[220:221], v[220:221], 1.0 op_sel_hi:[1,0]
    v_pk_add_f32 v[222:223], v[222:223], 1.0 op_sel_hi:[1,0]
    v_rcp_f32 v208, v208
    v_rcp_f32 v209, v209
    v_rcp_f32 v210, v210
    v_rcp_f32 v211, v211
    v_rcp_f32 v212, v212
    buffer_load_dwordx4 v[48:51], v52, s[12:15], 0 offen sc1
    v_rcp_f32 v213, v213
    v_rcp_f32 v214, v214
    v_rcp_f32 v215, v215
    v_rcp_f32 v216, v216
    v_rcp_f32 v217, v217
    v_rcp_f32 v218, v218
    v_rcp_f32 v219, v219
    v_rcp_f32 v220, v220
    v_rcp_f32 v221, v221
    buffer_load_dwordx4 v[56:59], v60, s[12:15], 0 offen sc1
    v_rcp_f32 v222, v222
    v_rcp_f32 v223, v223
    v_pk_mul_f32 v[208:209], v[208:209], v[96:97]
    v_pk_mul_f32 v[210:211], v[210:211], v[98:99]
    v_pk_mul_f32 v[212:213], v[212:213], v[104:105]
    v_pk_mul_f32 v[214:215], v[214:215], v[106:107]
    v_pk_mul_f32 v[216:217], v[216:217], v[112:113]
    v_pk_mul_f32 v[218:219], v[218:219], v[114:115]
    v_pk_mul_f32 v[220:221], v[220:221], v[120:121]
    v_pk_mul_f32 v[222:223], v[222:223], v[122:123]
    ds_read_b128 v[96:99], v247 offset:384
    ds_read_b128 v[104:107], v247 offset:448
    ds_read2_b32 v[112:113], v248 offset0:96 offset1:112
    v_cvt_pk_bf16_f32 v66, v208, v212
    v_cvt_pk_bf16_f32 v67, v216, v220
    v_cvt_pk_bf16_f32 v74, v209, v213
    v_cvt_pk_bf16_f32 v75, v217, v221
    v_cvt_pk_bf16_f32 v82, v210, v214
    v_cvt_pk_bf16_f32 v83, v218, v222
    v_cvt_pk_bf16_f32 v90, v211, v215
    v_cvt_pk_bf16_f32 v91, v219, v223
    s_waitcnt lgkmcnt(3)
    s_waitcnt vmcnt(14)
    v_fma_mix_f32 v208, v100, 1.0, v192 op_sel_hi:[1,0,0]
    v_fma_mix_f32 v212, v108, 1.0, v193 op_sel_hi:[1,0,0]
    v_mfma_f32_16x16x32_bf16 v[128:131], v[240:243], v[64:67], v[128:131]
    v_fma_mix_f32 v216, v116, 1.0, v194 op_sel_hi:[1,0,0]
    v_fma_mix_f32 v220, v124, 1.0, v195 op_sel_hi:[1,0,0]
    v_mfma_f32_16x16x32_bf16 v[132:135], v[240:243], v[72:75], v[132:135]
    v_fma_mix_f32 v209, v101, 1.0, v196 op_sel_hi:[1,0,0]
    v_fma_mix_f32 v213, v109, 1.0, v197 op_sel_hi:[1,0,0]
    v_mfma_f32_16x16x32_bf16 v[136:139], v[240:243], v[80:83], v[136:139]
    v_fma_mix_f32 v217, v117, 1.0, v198 op_sel_hi:[1,0,0]
    v_fma_mix_f32 v221, v125, 1.0, v199 op_sel_hi:[1,0,0]
    v_mfma_f32_16x16x32_bf16 v[140:143], v[240:243], v[88:91], v[140:143]
    v_fma_mix_f32 v210, v102, 1.0, v200 op_sel_hi:[1,0,0]
    v_fma_mix_f32 v214, v110, 1.0, v201 op_sel_hi:[1,0,0]
    v_fma_mix_f32 v218, v118, 1.0, v202 op_sel_hi:[1,0,0]
    v_fma_mix_f32 v222, v126, 1.0, v203 op_sel_hi:[1,0,0]
    v_fma_mix_f32 v211, v103, 1.0, v204 op_sel_hi:[1,0,0]
    v_fma_mix_f32 v215, v111, 1.0, v205 op_sel_hi:[1,0,0]
    v_fma_mix_f32 v219, v119, 1.0, v206 op_sel_hi:[1,0,0]
    v_fma_mix_f32 v223, v127, 1.0, v207 op_sel_hi:[1,0,0]
    s_waitcnt vmcnt(12) lgkmcnt(3)
    v_exp_f32 v208, v208
    v_mfma_f32_16x16x32_bf16 v[192:195], v[224:227], v[160:163], 0
    v_exp_f32 v209, v209
    v_mfma_f32_16x16x32_bf16 v[196:199], v[224:227], v[164:167], 0
    v_exp_f32 v210, v210
    v_mfma_f32_16x16x32_bf16 v[200:203], v[224:227], v[168:171], 0
    v_exp_f32 v211, v211
    v_mfma_f32_16x16x32_bf16 v[204:207], v[224:227], v[172:175], 0
    v_exp_f32 v212, v212
    v_exp_f32 v213, v213
    v_exp_f32 v214, v214
    v_exp_f32 v215, v215
    buffer_load_dwordx4 v[36:39], v36, s[12:15], 0 offen offset:256 sc1
    v_exp_f32 v216, v216
    v_exp_f32 v217, v217
    v_exp_f32 v218, v218
    v_exp_f32 v219, v219
    v_exp_f32 v220, v220
    v_exp_f32 v221, v221
    v_exp_f32 v222, v222
    v_exp_f32 v223, v223
    buffer_load_dwordx4 v[44:47], v44, s[12:15], 0 offen offset:256 sc1
    v_pk_add_f32 v[208:209], v[208:209], 1.0 op_sel_hi:[1,0]
    v_pk_add_f32 v[210:211], v[210:211], 1.0 op_sel_hi:[1,0]
    v_pk_add_f32 v[212:213], v[212:213], 1.0 op_sel_hi:[1,0]
    v_pk_add_f32 v[214:215], v[214:215], 1.0 op_sel_hi:[1,0]
    v_pk_add_f32 v[216:217], v[216:217], 1.0 op_sel_hi:[1,0]
    v_pk_add_f32 v[218:219], v[218:219], 1.0 op_sel_hi:[1,0]
    v_pk_add_f32 v[220:221], v[220:221], 1.0 op_sel_hi:[1,0]
    v_pk_add_f32 v[222:223], v[222:223], 1.0 op_sel_hi:[1,0]
    v_rcp_f32 v208, v208
    v_rcp_f32 v209, v209
    v_rcp_f32 v210, v210
    v_rcp_f32 v211, v211
    v_rcp_f32 v212, v212
    buffer_load_dwordx4 v[52:55], v52, s[12:15], 0 offen offset:256 sc1
    v_rcp_f32 v213, v213
    v_rcp_f32 v214, v214
    v_rcp_f32 v215, v215
    v_rcp_f32 v216, v216
    v_rcp_f32 v217, v217
    v_rcp_f32 v218, v218
    v_rcp_f32 v219, v219
    v_rcp_f32 v220, v220
    v_rcp_f32 v221, v221
    buffer_load_dwordx4 v[60:63], v60, s[12:15], 0 offen offset:256 sc1
    v_rcp_f32 v222, v222
    v_rcp_f32 v223, v223
    v_pk_mul_f32 v[208:209], v[208:209], v[100:101]
    v_pk_mul_f32 v[210:211], v[210:211], v[102:103]
    v_pk_mul_f32 v[212:213], v[212:213], v[108:109]
    v_pk_mul_f32 v[214:215], v[214:215], v[110:111]
    v_pk_mul_f32 v[216:217], v[216:217], v[116:117]
    v_pk_mul_f32 v[218:219], v[218:219], v[118:119]
    v_pk_mul_f32 v[220:221], v[220:221], v[124:125]
    v_pk_mul_f32 v[222:223], v[222:223], v[126:127]
    v_cvt_pk_bf16_f32 v70, v208, v212
    v_cvt_pk_bf16_f32 v71, v216, v220
    v_cvt_pk_bf16_f32 v78, v209, v213
    v_cvt_pk_bf16_f32 v79, v217, v221
    v_cvt_pk_bf16_f32 v86, v210, v214
    v_cvt_pk_bf16_f32 v87, v218, v222
    v_cvt_pk_bf16_f32 v94, v211, v215
    v_cvt_pk_bf16_f32 v95, v219, v223
    v_add_u32 v248, 256, v248
    v_add_u32 v249, 256, v249
    v_mfma_f32_16x16x32_bf16 v[144:147], v[240:243], v[68:71], v[144:147]
    v_mfma_f32_16x16x32_bf16 v[148:151], v[240:243], v[76:79], v[148:151]
    v_mfma_f32_16x16x32_bf16 v[152:155], v[240:243], v[84:87], v[152:155]
    v_mfma_f32_16x16x32_bf16 v[156:159], v[240:243], v[92:95], v[156:159]
    v_add_u32 v247, 256, v247
    s_cmp_lg_u32 s46, s60
    s_cbranch_scc1 K2_LOOP
K2_LAST0:
    s_cmp_eq_u32 s57, 0
    s_cbranch_scc1 K2_HALF0
    ds_read2_b32 v[240:241], v249 offset0:0 offset1:16
    s_waitcnt vmcnt(12)
    v_fma_mix_f32 v208, v0, 1.0, v192 op_sel_hi:[1,0,0]
    v_fma_mix_f32 v212, v8, 1.0, v193 op_sel_hi:[1,0,0]
    v_fma_mix_f32 v216, v16, 1.0, v194 op_sel_hi:[1,0,0]
    v_fma_mix_f32 v220, v24, 1.0, v195 op_sel_hi:[1,0,0]
    v_fma_mix_f32 v209, v1, 1.0, v196 op_sel_hi:[1,0,0]
    v_fma_mix_f32 v213, v9, 1.0, v197 op_sel_hi:[1,0,0]
    v_fma_mix_f32 v217, v17, 1.0, v198 op_sel_hi:[1,0,0]
    v_fma_mix_f32 v221, v25, 1.0, v199 op_sel_hi:[1,0,0]
    v_fma_mix_f32 v210, v2, 1.0, v200 op_sel_hi:[1,0,0]
    v_fma_mix_f32 v214, v10, 1.0, v201 op_sel_hi:[1,0,0]
    v_fma_mix_f32 v218, v18, 1.0, v202 op_sel_hi:[1,0,0]
    v_fma_mix_f32 v222, v26, 1.0, v203 op_sel_hi:[1,0,0]
    v_fma_mix_f32 v211, v3, 1.0, v204 op_sel_hi:[1,0,0]
    v_fma_mix_f32 v215, v11, 1.0, v205 op_sel_hi:[1,0,0]
    v_fma_mix_f32 v219, v19, 1.0, v206 op_sel_hi:[1,0,0]
    v_fma_mix_f32 v223, v27, 1.0, v207 op_sel_hi:[1,0,0]
    s_waitcnt lgkmcnt(0)
    v_and_or_b32 v242, v241, s54, v246
    v_and_or_b32 v240, v240, s54, v246
    ds_read_b64_tr_b16 v[242:243], v242
    ds_read_b64_tr_b16 v[240:241], v240
    v_exp_f32 v208, v208
    v_mfma_f32_16x16x32_bf16 v[192:195], v[224:227], v[176:179], 0
    v_exp_f32 v209, v209
    v_mfma_f32_16x16x32_bf16 v[196:199], v[224:227], v[180:183], 0
    v_exp_f32 v210, v210
    v_mfma_f32_16x16x32_bf16 v[200:203], v[224:227], v[184:187], 0
    v_exp_f32 v211, v211
    v_mfma_f32_16x16x32_bf16 v[204:207], v[224:227], v[188:191], 0
    v_exp_f32 v212, v212
    v_exp_f32 v213, v213
    v_exp_f32 v214, v214
    v_exp_f32 v215, v215
    v_exp_f32 v216, v216
    v_exp_f32 v217, v217
    v_exp_f32 v218, v218
    v_exp_f32 v219, v219
    v_exp_f32 v220, v220
    v_exp_f32 v221, v221
    v_exp_f32 v222, v222
    v_exp_f32 v223, v223
    v_pk_add_f32 v[208:209], v[208:209], 1.0 op_sel_hi:[1,0]
    v_pk_add_f32 v[210:211], v[210:211], 1.0 op_sel_hi:[1,0]
    v_pk_add_f32 v[212:213], v[212:213], 1.0 op_sel_hi:[1,0]
    v_pk_add_f32 v[214:215], v[214:215], 1.0 op_sel_hi:[1,0]
    v_pk_add_f32 v[216:217], v[216:217], 1.0 op_sel_hi:[1,0]
    v_pk_add_f32 v[218:219], v[218:219], 1.0 op_sel_hi:[1,0]
    v_pk_add_f32 v[220:221], v[220:221], 1.0 op_sel_hi:[1,0]
    v_pk_add_f32 v[222:223], v[222:223], 1.0 op_sel_hi:[1,0]
    v_rcp_f32 v208, v208
    v_rcp_f32 v209, v209
    v_rcp_f32 v210, v210
    v_rcp_f32 v211, v211
    v_rcp_f32 v212, v212
    v_rcp_f32 v213, v213
    v_rcp_f32 v214, v214
    v_rcp_f32 v215, v215
    v_rcp_f32 v216, v216
    v_rcp_f32 v217, v217
    v_rcp_f32 v218, v218
    v_rcp_f32 v219, v219
    v_rcp_f32 v220, v220
    v_rcp_f32 v221, v221
    v_rcp_f32 v222, v222
    v_rcp_f32 v223, v223
    v_pk_mul_f32 v[208:209], v[208:209], v[0:1]
    v_pk_mul_f32 v[210:211], v[210:211], v[2:3]
    v_pk_mul_f32 v[212:213], v[212:213], v[8:9]
    v_pk_mul_f32 v[214:215], v[214:215], v[10:11]
    v_pk_mul_f32 v[216:217], v[216:217], v[16:17]
    v_pk_mul_f32 v[218:219], v[218:219], v[18:19]
    v_pk_mul_f32 v[220:221], v[220:221], v[24:25]
    v_pk_mul_f32 v[222:223], v[222:223], v[26:27]
    v_cvt_pk_bf16_f32 v0, v208, v212
    v_cvt_pk_bf16_f32 v1, v216, v220
    v_cvt_pk_bf16_f32 v8, v209, v213
    v_cvt_pk_bf16_f32 v9, v217, v221
    v_cvt_pk_bf16_f32 v16, v210, v214
    v_cvt_pk_bf16_f32 v17, v218, v222
    v_cvt_pk_bf16_f32 v24, v211, v215
    v_cvt_pk_bf16_f32 v25, v219, v223
    s_waitcnt vmcnt(8)
    v_fma_mix_f32 v208, v4, 1.0, v192 op_sel_hi:[1,0,0]
    v_fma_mix_f32 v212, v12, 1.0, v193 op_sel_hi:[1,0,0]
    v_fma_mix_f32 v216, v20, 1.0, v194 op_sel_hi:[1,0,0]
    v_fma_mix_f32 v220, v28, 1.0, v195 op_sel_hi:[1,0,0]
    v_fma_mix_f32 v209, v5, 1.0, v196 op_sel_hi:[1,0,0]
    v_fma_mix_f32 v213, v13, 1.0, v197 op_sel_hi:[1,0,0]
    v_fma_mix_f32 v217, v21, 1.0, v198 op_sel_hi:[1,0,0]
    v_fma_mix_f32 v221, v29, 1.0, v199 op_sel_hi:[1,0,0]
    v_fma_mix_f32 v210, v6, 1.0, v200 op_sel_hi:[1,0,0]
    v_fma_mix_f32 v214, v14, 1.0, v201 op_sel_hi:[1,0,0]
    v_fma_mix_f32 v218, v22, 1.0, v202 op_sel_hi:[1,0,0]
    v_fma_mix_f32 v222, v30, 1.0, v203 op_sel_hi:[1,0,0]
    v_fma_mix_f32 v211, v7, 1.0, v204 op_sel_hi:[1,0,0]
    v_fma_mix_f32 v215, v15, 1.0, v205 op_sel_hi:[1,0,0]
    v_fma_mix_f32 v219, v23, 1.0, v206 op_sel_hi:[1,0,0]
    v_fma_mix_f32 v223, v31, 1.0, v207 op_sel_hi:[1,0,0]
    v_exp_f32 v208, v208
    v_mfma_f32_16x16x32_bf16 v[192:195], v[228:231], v[160:163], 0
    v_exp_f32 v209, v209
    v_mfma_f32_16x16x32_bf16 v[196:199], v[228:231], v[164:167], 0
    v_exp_f32 v210, v210
    v_mfma_f32_16x16x32_bf16 v[200:203], v[228:231], v[168:171], 0
    v_exp_f32 v211, v211
    v_mfma_f32_16x16x32_bf16 v[204:207], v[228:231], v[172:175], 0
    v_exp_f32 v212, v212
    v_exp_f32 v213, v213
    v_exp_f32 v214, v214
    v_exp_f32 v215, v215
    v_exp_f32 v216, v216
    v_exp_f32 v217, v217
    v_exp_f32 v218, v218
    v_exp_f32 v219, v219
    v_exp_f32 v220, v220
    v_exp_f32 v221, v221
    v_exp_f32 v222, v222
    v_exp_f32 v223, v223
    v_pk_add_f32 v[208:209], v[208:209], 1.0 op_sel_hi:[1,0]
    v_pk_add_f32 v[210:211], v[210:211], 1.0 op_sel_hi:[1,0]
    v_pk_add_f32 v[212:213], v[212:213], 1.0 op_sel_hi:[1,0]
    v_pk_add_f32 v[214:215], v[214:215], 1.0 op_sel_hi:[1,0]
    v_pk_add_f32 v[216:217], v[216:217], 1.0 op_sel_hi:[1,0]
    v_pk_add_f32 v[218:219], v[218:219], 1.0 op_sel_hi:[1,0]
    v_pk_add_f32 v[220:221], v[220:221], 1.0 op_sel_hi:[1,0]
    v_pk_add_f32 v[222:223], v[222:223], 1.0 op_sel_hi:[1,0]
    v_rcp_f32 v208, v208
    v_rcp_f32 v209, v209
    v_rcp_f32 v210, v210
    v_rcp_f32 v211, v211
    v_rcp_f32 v212, v212
    v_rcp_f32 v213, v213
    v_rcp_f32 v214, v214
    v_rcp_f32 v215, v215
    v_rcp_f32 v216, v216
    v_rcp_f32 v217, v217
    v_rcp_f32 v218, v218
    v_rcp_f32 v219, v219
    v_rcp_f32 v220, v220
    v_rcp_f32 v221, v221
    v_rcp_f32 v222, v222
    v_rcp_f32 v223, v223
    v_pk_mul_f32 v[208:209], v[208:209], v[4:5]
    v_pk_mul_f32 v[210:211], v[210:211], v[6:7]
    v_pk_mul_f32 v[212:213], v[212:213], v[12:13]
    v_pk_mul_f32 v[214:215], v[214:215], v[14:15]
    v_pk_mul_f32 v[216:217], v[216:217], v[20:21]
    v_pk_mul_f32 v[218:219], v[218:219], v[22:23]
    v_pk_mul_f32 v[220:221], v[220:221], v[28:29]
    v_pk_mul_f32 v[222:223], v[222:223], v[30:31]
    v_cvt_pk_bf16_f32 v4, v208, v212
    v_cvt_pk_bf16_f32 v5, v216, v220
    v_cvt_pk_bf16_f32 v12, v209, v213
    v_cvt_pk_bf16_f32 v13, v217, v221
    v_cvt_pk_bf16_f32 v20, v210, v214
    v_cvt_pk_bf16_f32 v21, v218, v222
    v_cvt_pk_bf16_f32 v28, v211, v215
    v_cvt_pk_bf16_f32 v29, v219, v223
    s_waitcnt vmcnt(4)
    v_fma_mix_f32 v208, v32, 1.0, v192 op_sel_hi:[1,0,0]
    v_fma_mix_f32 v209, v33, 1.0, v196 op_sel_hi:[1,0,0]
    v_fma_mix_f32 v210, v34, 1.0, v200 op_sel_hi:[1,0,0]
    v_fma_mix_f32 v211, v35, 1.0, v204 op_sel_hi:[1,0,0]
    s_cmp_le_u32 s59, 1
    s_cbranch_scc1 K2_L02_M2
    v_fma_mix_f32 v212, v40, 1.0, v193 op_sel_hi:[1,0,0]
    v_fma_mix_f32 v213, v41, 1.0, v197 op_sel_hi:[1,0,0]
    v_fma_mix_f32 v214, v42, 1.0, v201 op_sel_hi:[1,0,0]
    v_fma_mix_f32 v215, v43, 1.0, v205 op_sel_hi:[1,0,0]
    s_cmp_le_u32 s59, 2
    s_cbranch_scc1 K2_L02_M2
    v_fma_mix_f32 v216, v48, 1.0, v194 op_sel_hi:[1,0,0]
    v_fma_mix_f32 v217, v49, 1.0, v198 op_sel_hi:[1,0,0]
    v_fma_mix_f32 v218, v50, 1.0, v202 op_sel_hi:[1,0,0]
    v_fma_mix_f32 v219, v51, 1.0, v206 op_sel_hi:[1,0,0]
    s_cmp_le_u32 s59, 3
    s_cbranch_scc1 K2_L02_M2
    v_fma_mix_f32 v220, v56, 1.0, v195 op_sel_hi:[1,0,0]
    v_fma_mix_f32 v221, v57, 1.0, v199 op_sel_hi:[1,0,0]
    v_fma_mix_f32 v222, v58, 1.0, v203 op_sel_hi:[1,0,0]
    v_fma_mix_f32 v223, v59, 1.0, v207 op_sel_hi:[1,0,0]
K2_L02_M2:
    v_exp_f32 v208, v208
    v_mfma_f32_16x16x32_bf16 v[192:195], v[228:231], v[176:179], 0
    v_exp_f32 v209, v209
    v_mfma_f32_16x16x32_bf16 v[196:199], v[228:231], v[180:183], 0
    v_exp_f32 v210, v210
    v_mfma_f32_16x16x32_bf16 v[200:203], v[228:231], v[184:187], 0
    v_exp_f32 v211, v211
    v_mfma_f32_16x16x32_bf16 v[204:207], v[228:231], v[188:191], 0
    v_pk_add_f32 v[208:209], v[208:209], 1.0 op_sel_hi:[1,0]
    v_pk_add_f32 v[210:211], v[210:211], 1.0 op_sel_hi:[1,0]
    v_rcp_f32 v208, v208
    v_rcp_f32 v209, v209
    v_rcp_f32 v210, v210
    v_rcp_f32 v211, v211
    v_pk_mul_f32 v[208:209], v[208:209], v[32:33]
    v_pk_mul_f32 v[210:211], v[210:211], v[34:35]
    s_cmp_le_u32 s59, 1
    s_cbranch_scc1 K2_L02_C2
    v_exp_f32 v212, v212
    v_exp_f32 v213, v213
    v_exp_f32 v214, v214
    v_exp_f32 v215, v215
    v_pk_add_f32 v[212:213], v[212:213], 1.0 op_sel_hi:[1,0]
    v_pk_add_f32 v[214:215], v[214:215], 1.0 op_sel_hi:[1,0]
    v_rcp_f32 v212, v212
    v_rcp_f32 v213, v213
    v_rcp_f32 v214, v214
    v_rcp_f32 v215, v215
    v_pk_mul_f32 v[212:213], v[212:213], v[40:41]
    v_pk_mul_f32 v[214:215], v[214:215], v[42:43]
    s_cmp_le_u32 s59, 2
    s_cbranch_scc1 K2_L02_C2
    v_exp_f32 v216, v216
    v_exp_f32 v217, v217
    v_exp_f32 v218, v218
    v_exp_f32 v219, v219
    v_pk_add_f32 v[216:217], v[216:217], 1.0 op_sel_hi:[1,0]
    v_pk_add_f32 v[218:219], v[218:219], 1.0 op_sel_hi:[1,0]
    v_rcp_f32 v216, v216
    v_rcp_f32 v217, v217
    v_rcp_f32 v218, v218
    v_rcp_f32 v219, v219
    v_pk_mul_f32 v[216:217], v[216:217], v[48:49]
    v_pk_mul_f32 v[218:219], v[218:219], v[50:51]
    s_cmp_le_u32 s59, 3
    s_cbranch_scc1 K2_L02_C2
    v_exp_f32 v220, v220
    v_exp_f32 v221, v221
    v_exp_f32 v222, v222
    v_exp_f32 v223, v223
    v_pk_add_f32 v[220:221], v[220:221], 1.0 op_sel_hi:[1,0]
    v_pk_add_f32 v[222:223], v[222:223], 1.0 op_sel_hi:[1,0]
    v_rcp_f32 v220, v220
    v_rcp_f32 v221, v221
    v_rcp_f32 v222, v222
    v_rcp_f32 v223, v223
    v_pk_mul_f32 v[220:221], v[220:221], v[56:57]
    v_pk_mul_f32 v[222:223], v[222:223], v[58:59]
K2_L02_C2:
    v_cvt_pk_bf16_f32 v2, v208, v212
    v_cvt_pk_bf16_f32 v3, v216, v220
    v_cvt_pk_bf16_f32 v10, v209, v213
    v_cvt_pk_bf16_f32 v11, v217, v221
    v_cvt_pk_bf16_f32 v18, v210, v214
    v_cvt_pk_bf16_f32 v19, v218, v222
    v_cvt_pk_bf16_f32 v26, v211, v215
    v_cvt_pk_bf16_f32 v27, v219, v223
    s_waitcnt lgkmcnt(0)
    s_waitcnt vmcnt(0)
    v_mfma_f32_16x16x32_bf16 v[128:131], v[240:243], v[0:3], v[128:131]
    v_mfma_f32_16x16x32_bf16 v[132:135], v[240:243], v[8:11], v[132:135]
    v_mfma_f32_16x16x32_bf16 v[136:139], v[240:243], v[16:19], v[136:139]
    v_mfma_f32_16x16x32_bf16 v[140:143], v[240:243], v[24:27], v[140:143]
    v_fma_mix_f32 v208, v36, 1.0, v192 op_sel_hi:[1,0,0]
    v_fma_mix_f32 v209, v37, 1.0, v196 op_sel_hi:[1,0,0]
    v_fma_mix_f32 v210, v38, 1.0, v200 op_sel_hi:[1,0,0]
    v_fma_mix_f32 v211, v39, 1.0, v204 op_sel_hi:[1,0,0]
    s_cmp_le_u32 s59, 1
    s_cbranch_scc1 K2_L02_M3
    v_fma_mix_f32 v212, v44, 1.0, v193 op_sel_hi:[1,0,0]
    v_fma_mix_f32 v213, v45, 1.0, v197 op_sel_hi:[1,0,0]
    v_fma_mix_f32 v214, v46, 1.0, v201 op_sel_hi:[1,0,0]
    v_fma_mix_f32 v215, v47, 1.0, v205 op_sel_hi:[1,0,0]
    s_cmp_le_u32 s59, 2
    s_cbranch_scc1 K2_L02_M3
    v_fma_mix_f32 v216, v52, 1.0, v194 op_sel_hi:[1,0,0]
    v_fma_mix_f32 v217, v53, 1.0, v198 op_sel_hi:[1,0,0]
    v_fma_mix_f32 v218, v54, 1.0, v202 op_sel_hi:[1,0,0]
    v_fma_mix_f32 v219, v55, 1.0, v206 op_sel_hi:[1,0,0]
    s_cmp_le_u32 s59, 3
    s_cbranch_scc1 K2_L02_M3
    v_fma_mix_f32 v220, v60, 1.0, v195 op_sel_hi:[1,0,0]
    v_fma_mix_f32 v221, v61, 1.0, v199 op_sel_hi:[1,0,0]
    v_fma_mix_f32 v222, v62, 1.0, v203 op_sel_hi:[1,0,0]
    v_fma_mix_f32 v223, v63, 1.0, v207 op_sel_hi:[1,0,0]
K2_L02_M3:
    v_exp_f32 v208, v208
    v_exp_f32 v209, v209
    v_exp_f32 v210, v210
    v_exp_f32 v211, v211
    v_pk_add_f32 v[208:209], v[208:209], 1.0 op_sel_hi:[1,0]
    v_pk_add_f32 v[210:211], v[210:211], 1.0 op_sel_hi:[1,0]
    v_rcp_f32 v208, v208
    v_rcp_f32 v209, v209
    v_rcp_f32 v210, v210
    v_rcp_f32 v211, v211
    v_pk_mul_f32 v[208:209], v[208:209], v[36:37]
    v_pk_mul_f32 v[210:211], v[210:211], v[38:39]
    s_cmp_le_u32 s59, 1
    s_cbranch_scc1 K2_L02_C3
    v_exp_f32 v212, v212
    v_exp_f32 v213, v213
    v_exp_f32 v214, v214
    v_exp_f32 v215, v215
    v_pk_add_f32 v[212:213], v[212:213], 1.0 op_sel_hi:[1,0]
    v_pk_add_f32 v[214:215], v[214:215], 1.0 op_sel_hi:[1,0]
    v_rcp_f32 v212, v212
    v_rcp_f32 v213, v213
    v_rcp_f32 v214, v214
    v_rcp_f32 v215, v215
    v_pk_mul_f32 v[212:213], v[212:213], v[44:45]
    v_pk_mul_f32 v[214:215], v[214:215], v[46:47]
    s_cmp_le_u32 s59, 2
    s_cbranch_scc1 K2_L02_C3
    v_exp_f32 v216, v216
    v_exp_f32 v217, v217
    v_exp_f32 v218, v218
    v_exp_f32 v219, v219
    v_pk_add_f32 v[216:217], v[216:217], 1.0 op_sel_hi:[1,0]
    v_pk_add_f32 v[218:219], v[218:219], 1.0 op_sel_hi:[1,0]
    v_rcp_f32 v216, v216
    v_rcp_f32 v217, v217
    v_rcp_f32 v218, v218
    v_rcp_f32 v219, v219
    v_pk_mul_f32 v[216:217], v[216:217], v[52:53]
    v_pk_mul_f32 v[218:219], v[218:219], v[54:55]
    s_cmp_le_u32 s59, 3
    s_cbranch_scc1 K2_L02_C3
    v_exp_f32 v220, v220
    v_exp_f32 v221, v221
    v_exp_f32 v222, v222
    v_exp_f32 v223, v223
    v_pk_add_f32 v[220:221], v[220:221], 1.0 op_sel_hi:[1,0]
    v_pk_add_f32 v[222:223], v[222:223], 1.0 op_sel_hi:[1,0]
    v_rcp_f32 v220, v220
    v_rcp_f32 v221, v221
    v_rcp_f32 v222, v222
    v_rcp_f32 v223, v223
    v_pk_mul_f32 v[220:221], v[220:221], v[60:61]
    v_pk_mul_f32 v[222:223], v[222:223], v[62:63]
K2_L02_C3:
    v_cvt_pk_bf16_f32 v6, v208, v212
    v_cvt_pk_bf16_f32 v7, v216, v220
    v_cvt_pk_bf16_f32 v14, v209, v213
    v_cvt_pk_bf16_f32 v15, v217, v221
    v_cvt_pk_bf16_f32 v22, v210, v214
    v_cvt_pk_bf16_f32 v23, v218, v222
    v_cvt_pk_bf16_f32 v30, v211, v215
    v_cvt_pk_bf16_f32 v31, v219, v223
    s_waitcnt lgkmcnt(0)
    s_nop 0
    v_mfma_f32_16x16x32_bf16 v[144:147], v[240:243], v[4:7], v[144:147]
    v_mfma_f32_16x16x32_bf16 v[148:151], v[240:243], v[12:15], v[148:151]
    v_mfma_f32_16x16x32_bf16 v[152:155], v[240:243], v[20:23], v[152:155]
    v_mfma_f32_16x16x32_bf16 v[156:159], v[240:243], v[28:31], v[156:159]
    s_branch K2_TDONE
K2_HALF0:
    ds_read2_b32 v[240:241], v249 offset0:0 offset1:16
    s_waitcnt vmcnt(12)
    v_fma_mix_f32 v208, v0, 1.0, v192 op_sel_hi:[1,0,0]
    v_fma_mix_f32 v209, v1, 1.0, v196 op_sel_hi:[1,0,0]
    v_fma_mix_f32 v210, v2, 1.0, v200 op_sel_hi:[1,0,0]
    v_fma_mix_f32 v211, v3, 1.0, v204 op_sel_hi:[1,0,0]
    s_cmp_le_u32 s59, 1
    s_cbranch_scc1 K2_L01_M0
    v_fma_mix_f32 v212, v8, 1.0, v193 op_sel_hi:[1,0,0]
    v_fma_mix_f32 v213, v9, 1.0, v197 op_sel_hi:[1,0,0]
    v_fma_mix_f32 v214, v10, 1.0, v201 op_sel_hi:[1,0,0]
    v_fma_mix_f32 v215, v11, 1.0, v205 op_sel_hi:[1,0,0]
    s_cmp_le_u32 s59, 2
    s_cbranch_scc1 K2_L01_M0
    v_fma_mix_f32 v216, v16, 1.0, v194 op_sel_hi:[1,0,0]
    v_fma_mix_f32 v217, v17, 1.0, v198 op_sel_hi:[1,0,0]
    v_fma_mix_f32 v218, v18, 1.0, v202 op_sel_hi:[1,0,0]
    v_fma_mix_f32 v219, v19, 1.0, v206 op_sel_hi:[1,0,0]
    s_cmp_le_u32 s59, 3
    s_cbranch_scc1 K2_L01_M0
    v_fma_mix_f32 v220, v24, 1.0, v195 op_sel_hi:[1,0,0]
    v_fma_mix_f32 v221, v25, 1.0, v199 op_sel_hi:[1,0,0]
    v_fma_mix_f32 v222, v26, 1.0, v203 op_sel_hi:[1,0,0]
    v_fma_mix_f32 v223, v27, 1.0, v207 op_sel_hi:[1,0,0]
K2_L01_M0:
    s_waitcnt lgkmcnt(0)
    v_and_or_b32 v242, v241, s54, v246
    v_and_or_b32 v240, v240, s54, v246
    ds_read_b64_tr_b16 v[242:243], v242
    ds_read_b64_tr_b16 v[240:241], v240
    v_exp_f32 v208, v208
    v_mfma_f32_16x16x32_bf16 v[192:195], v[224:227], v[176:179], 0
    v_exp_f32 v209, v209
    v_mfma_f32_16x16x32_bf16 v[196:199], v[224:227], v[180:183], 0
    v_exp_f32 v210, v210
    v_mfma_f32_16x16x32_bf16 v[200:203], v[224:227], v[184:187], 0
    v_exp_f32 v211, v211
    v_mfma_f32_16x16x32_bf16 v[204:207], v[224:227], v[188:191], 0
    v_pk_add_f32 v[208:209], v[208:209], 1.0 op_sel_hi:[1,0]
    v_pk_add_f32 v[210:211], v[210:211], 1.0 op_sel_hi:[1,0]
    v_rcp_f32 v208, v208
    v_rcp_f32 v209, v209
    v_rcp_f32 v210, v210
    v_rcp_f32 v211, v211
    v_pk_mul_f32 v[208:209], v[208:209], v[0:1]
    v_pk_mul_f32 v[210:211], v[210:211], v[2:3]
    s_cmp_le_u32 s59, 1
    s_cbranch_scc1 K2_L01_C0
    v_exp_f32 v212, v212
    v_exp_f32 v213, v213
    v_exp_f32 v214, v214
    v_exp_f32 v215, v215
    v_pk_add_f32 v[212:213], v[212:213], 1.0 op_sel_hi:[1,0]
    v_pk_add_f32 v[214:215], v[214:215], 1.0 op_sel_hi:[1,0]
    v_rcp_f32 v212, v212
    v_rcp_f32 v213, v213
    v_rcp_f32 v214, v214
    v_rcp_f32 v215, v215
    v_pk_mul_f32 v[212:213], v[212:213], v[8:9]
    v_pk_mul_f32 v[214:215], v[214:215], v[10:11]
    s_cmp_le_u32 s59, 2
    s_cbranch_scc1 K2_L01_C0
    v_exp_f32 v216, v216
    v_exp_f32 v217, v217
    v_exp_f32 v218, v218
    v_exp_f32 v219, v219
    v_pk_add_f32 v[216:217], v[216:217], 1.0 op_sel_hi:[1,0]
    v_pk_add_f32 v[218:219], v[218:219], 1.0 op_sel_hi:[1,0]
    v_rcp_f32 v216, v216
    v_rcp_f32 v217, v217
    v_rcp_f32 v218, v218
    v_rcp_f32 v219, v219
    v_pk_mul_f32 v[216:217], v[216:217], v[16:17]
    v_pk_mul_f32 v[218:219], v[218:219], v[18:19]
    s_cmp_le_u32 s59, 3
    s_cbranch_scc1 K2_L01_C0
    v_exp_f32 v220, v220
    v_exp_f32 v221, v221
    v_exp_f32 v222, v222
    v_exp_f32 v223, v223
    v_pk_add_f32 v[220:221], v[220:221], 1.0 op_sel_hi:[1,0]
    v_pk_add_f32 v[222:223], v[222:223], 1.0 op_sel_hi:[1,0]
    v_rcp_f32 v220, v220
    v_rcp_f32 v221, v221
    v_rcp_f32 v222, v222
    v_rcp_f32 v223, v223
    v_pk_mul_f32 v[220:221], v[220:221], v[24:25]
    v_pk_mul_f32 v[222:223], v[222:223], v[26:27]
K2_L01_C0:
    v_cvt_pk_bf16_f32 v0, v208, v212
    v_cvt_pk_bf16_f32 v1, v216, v220
    v_cvt_pk_bf16_f32 v8, v209, v213
    v_cvt_pk_bf16_f32 v9, v217, v221
    v_cvt_pk_bf16_f32 v16, v210, v214
    v_cvt_pk_bf16_f32 v17, v218, v222
    v_cvt_pk_bf16_f32 v24, v211, v215
    v_cvt_pk_bf16_f32 v25, v219, v223
    s_waitcnt lgkmcnt(0)
    s_waitcnt vmcnt(8)
    v_mfma_f32_16x16x16_bf16 v[128:131], v[240:241], v[0:1], v[128:131]
    v_mfma_f32_16x16x16_bf16 v[132:135], v[240:241], v[8:9], v[132:135]
    v_mfma_f32_16x16x16_bf16 v[136:139], v[240:241], v[16:17], v[136:139]
    v_mfma_f32_16x16x16_bf16 v[140:143], v[240:241], v[24:25], v[140:143]
    v_fma_mix_f32 v208, v4, 1.0, v192 op_sel_hi:[1,0,0]
    v_fma_mix_f32 v209, v5, 1.0, v196 op_sel_hi:[1,0,0]
    v_fma_mix_f32 v210, v6, 1.0, v200 op_sel_hi:[1,0,0]
    v_fma_mix_f32 v211, v7, 1.0, v204 op_sel_hi:[1,0,0]
    s_cmp_le_u32 s59, 1
    s_cbranch_scc1 K2_L01_M1
    v_fma_mix_f32 v212, v12, 1.0, v193 op_sel_hi:[1,0,0]
    v_fma_mix_f32 v213, v13, 1.0, v197 op_sel_hi:[1,0,0]
    v_fma_mix_f32 v214, v14, 1.0, v201 op_sel_hi:[1,0,0]
    v_fma_mix_f32 v215, v15, 1.0, v205 op_sel_hi:[1,0,0]
    s_cmp_le_u32 s59, 2
    s_cbranch_scc1 K2_L01_M1
    v_fma_mix_f32 v216, v20, 1.0, v194 op_sel_hi:[1,0,0]
    v_fma_mix_f32 v217, v21, 1.0, v198 op_sel_hi:[1,0,0]
    v_fma_mix_f32 v218, v22, 1.0, v202 op_sel_hi:[1,0,0]
    v_fma_mix_f32 v219, v23, 1.0, v206 op_sel_hi:[1,0,0]
    s_cmp_le_u32 s59, 3
    s_cbranch_scc1 K2_L01_M1
    v_fma_mix_f32 v220, v28, 1.0, v195 op_sel_hi:[1,0,0]
    v_fma_mix_f32 v221, v29, 1.0, v199 op_sel_hi:[1,0,0]
    v_fma_mix_f32 v222, v30, 1.0, v203 op_sel_hi:[1,0,0]
    v_fma_mix_f32 v223, v31, 1.0, v207 op_sel_hi:[1,0,0]
K2_L01_M1:
    v_exp_f32 v208, v208
    v_exp_f32 v209, v209
    v_exp_f32 v210, v210
    v_exp_f32 v211, v211
    v_pk_add_f32 v[208:209], v[208:209], 1.0 op_sel_hi:[1,0]
    v_pk_add_f32 v[210:211], v[210:211], 1.0 op_sel_hi:[1,0]
    v_rcp_f32 v208, v208
    v_rcp_f32 v209, v209
    v_rcp_f32 v210, v210
    v_rcp_f32 v211, v211
    v_pk_mul_f32 v[208:209], v[208:209], v[4:5]
    v_pk_mul_f32 v[210:211], v[210:211], v[6:7]
    s_cmp_le_u32 s59, 1
    s_cbranch_scc1 K2_L01_C1
    v_exp_f32 v212, v212
    v_exp_f32 v213, v213
    v_exp_f32 v214, v214
    v_exp_f32 v215, v215
    v_pk_add_f32 v[212:213], v[212:213], 1.0 op_sel_hi:[1,0]
    v_pk_add_f32 v[214:215], v[214:215], 1.0 op_sel_hi:[1,0]
    v_rcp_f32 v212, v212
    v_rcp_f32 v213, v213
    v_rcp_f32 v214, v214
    v_rcp_f32 v215, v215
    v_pk_mul_f32 v[212:213], v[212:213], v[12:13]
    v_pk_mul_f32 v[214:215], v[214:215], v[14:15]
    s_cmp_le_u32 s59, 2
    s_cbranch_scc1 K2_L01_C1
    v_exp_f32 v216, v216
    v_exp_f32 v217, v217
    v_exp_f32 v218, v218
    v_exp_f32 v219, v219
    v_pk_add_f32 v[216:217], v[216:217], 1.0 op_sel_hi:[1,0]
    v_pk_add_f32 v[218:219], v[218:219], 1.0 op_sel_hi:[1,0]
    v_rcp_f32 v216, v216
    v_rcp_f32 v217, v217
    v_rcp_f32 v218, v218
    v_rcp_f32 v219, v219
    v_pk_mul_f32 v[216:217], v[216:217], v[20:21]
    v_pk_mul_f32 v[218:219], v[218:219], v[22:23]
    s_cmp_le_u32 s59, 3
    s_cbranch_scc1 K2_L01_C1
    v_exp_f32 v220, v220
    v_exp_f32 v221, v221
    v_exp_f32 v222, v222
    v_exp_f32 v223, v223
    v_pk_add_f32 v[220:221], v[220:221], 1.0 op_sel_hi:[1,0]
    v_pk_add_f32 v[222:223], v[222:223], 1.0 op_sel_hi:[1,0]
    v_rcp_f32 v220, v220
    v_rcp_f32 v221, v221
    v_rcp_f32 v222, v222
    v_rcp_f32 v223, v223
    v_pk_mul_f32 v[220:221], v[220:221], v[28:29]
    v_pk_mul_f32 v[222:223], v[222:223], v[30:31]
K2_L01_C1:
    v_cvt_pk_bf16_f32 v4, v208, v212
    v_cvt_pk_bf16_f32 v5, v216, v220
    v_cvt_pk_bf16_f32 v12, v209, v213
    v_cvt_pk_bf16_f32 v13, v217, v221
    v_cvt_pk_bf16_f32 v20, v210, v214
    v_cvt_pk_bf16_f32 v21, v218, v222
    v_cvt_pk_bf16_f32 v28, v211, v215
    v_cvt_pk_bf16_f32 v29, v219, v223
    s_waitcnt lgkmcnt(0)
    s_nop 0
    v_mfma_f32_16x16x16_bf16 v[144:147], v[240:241], v[4:5], v[144:147]
    v_mfma_f32_16x16x16_bf16 v[148:151], v[240:241], v[12:13], v[148:151]
    v_mfma_f32_16x16x16_bf16 v[152:155], v[240:241], v[20:21], v[152:155]
    v_mfma_f32_16x16x16_bf16 v[156:159], v[240:241], v[28:29], v[156:159]
    s_branch K2_TDONE
K2_LAST1:
    s_cmp_eq_u32 s57, 0
    s_cbranch_scc1 K2_HALF1
    ds_read2_b32 v[240:241], v249 offset0:32 offset1:48
    s_waitcnt vmcnt(12)
    v_fma_mix_f32 v208, v64, 1.0, v192 op_sel_hi:[1,0,0]
    v_fma_mix_f32 v212, v72, 1.0, v193 op_sel_hi:[1,0,0]
    v_fma_mix_f32 v216, v80, 1.0, v194 op_sel_hi:[1,0,0]
    v_fma_mix_f32 v220, v88, 1.0, v195 op_sel_hi:[1,0,0]
    v_fma_mix_f32 v209, v65, 1.0, v196 op_sel_hi:[1,0,0]
    v_fma_mix_f32 v213, v73, 1.0, v197 op_sel_hi:[1,0,0]
    v_fma_mix_f32 v217, v81, 1.0, v198 op_sel_hi:[1,0,0]
    v_fma_mix_f32 v221, v89, 1.0, v199 op_sel_hi:[1,0,0]
    v_fma_mix_f32 v210, v66, 1.0, v200 op_sel_hi:[1,0,0]
    v_fma_mix_f32 v214, v74, 1.0, v201 op_sel_hi:[1,0,0]
    v_fma_mix_f32 v218, v82, 1.0, v202 op_sel_hi:[1,0,0]
    v_fma_mix_f32 v222, v90, 1.0, v203 op_sel_hi:[1,0,0]
    v_fma_mix_f32 v211, v67, 1.0, v204 op_sel_hi:[1,0,0]
    v_fma_mix_f32 v215, v75, 1.0, v205 op_sel_hi:[1,0,0]
    v_fma_mix_f32 v219, v83, 1.0, v206 op_sel_hi:[1,0,0]
    v_fma_mix_f32 v223, v91, 1.0, v207 op_sel_hi:[1,0,0]
    s_waitcnt lgkmcnt(0)
    v_and_or_b32 v242, v241, s54, v246
    v_and_or_b32 v240, v240, s54, v246
    ds_read_b64_tr_b16 v[242:243], v242
    ds_read_b64_tr_b16 v[240:241], v240
    v_exp_f32 v208, v208
    v_mfma_f32_16x16x32_bf16 v[192:195], v[232:235], v[176:179], 0
    v_exp_f32 v209, v209
    v_mfma_f32_16x16x32_bf16 v[196:199], v[232:235], v[180:183], 0
    v_exp_f32 v210, v210
    v_mfma_f32_16x16x32_bf16 v[200:203], v[232:235], v[184:187], 0
    v_exp_f32 v211, v211
    v_mfma_f32_16x16x32_bf16 v[204:207], v[232:235], v[188:191], 0
    v_exp_f32 v212, v212
    v_exp_f32 v213, v213
    v_exp_f32 v214, v214
    v_exp_f32 v215, v215
    v_exp_f32 v216, v216
    v_exp_f32 v217, v217
    v_exp_f32 v218, v218
    v_exp_f32 v219, v219
    v_exp_f32 v220, v220
    v_exp_f32 v221, v221
    v_exp_f32 v222, v222
    v_exp_f32 v223, v223
    v_pk_add_f32 v[208:209], v[208:209], 1.0 op_sel_hi:[1,0]
    v_pk_add_f32 v[210:211], v[210:211], 1.0 op_sel_hi:[1,0]
    v_pk_add_f32 v[212:213], v[212:213], 1.0 op_sel_hi:[1,0]
    v_pk_add_f32 v[214:215], v[214:215], 1.0 op_sel_hi:[1,0]
    v_pk_add_f32 v[216:217], v[216:217], 1.0 op_sel_hi:[1,0]
    v_pk_add_f32 v[218:219], v[218:219], 1.0 op_sel_hi:[1,0]
    v_pk_add_f32 v[220:221], v[220:221], 1.0 op_sel_hi:[1,0]
    v_pk_add_f32 v[222:223], v[222:223], 1.0 op_sel_hi:[1,0]
    v_rcp_f32 v208, v208
    v_rcp_f32 v209, v209
    v_rcp_f32 v210, v210
    v_rcp_f32 v211, v211
    v_rcp_f32 v212, v212
    v_rcp_f32 v213, v213
    v_rcp_f32 v214, v214
    v_rcp_f32 v215, v215
    v_rcp_f32 v216, v216
    v_rcp_f32 v217, v217
    v_rcp_f32 v218, v218
    v_rcp_f32 v219, v219
    v_rcp_f32 v220, v220
    v_rcp_f32 v221, v221
    v_rcp_f32 v222, v222
    v_rcp_f32 v223, v223
    v_pk_mul_f32 v[208:209], v[208:209], v[64:65]
    v_pk_mul_f32 v[210:211], v[210:211], v[66:67]
    v_pk_mul_f32 v[212:213], v[212:213], v[72:73]
    v_pk_mul_f32 v[214:215], v[214:215], v[74:75]
    v_pk_mul_f32 v[216:217], v[216:217], v[80:81]
    v_pk_mul_f32 v[218:219], v[218:219], v[82:83]
    v_pk_mul_f32 v[220:221], v[220:221], v[88:89]
    v_pk_mul_f32 v[222:223], v[222:223], v[90:91]
    v_cvt_pk_bf16_f32 v64, v208, v212
    v_cvt_pk_bf16_f32 v65, v216, v220
    v_cvt_pk_bf16_f32 v72, v209, v213
    v_cvt_pk_bf16_f32 v73, v217, v221
    v_cvt_pk_bf16_f32 v80, v210, v214
    v_cvt_pk_bf16_f32 v81, v218, v222
    v_cvt_pk_bf16_f32 v88, v211, v215
    v_cvt_pk_bf16_f32 v89, v219, v223
    s_waitcnt vmcnt(8)
    v_fma_mix_f32 v208, v68, 1.0, v192 op_sel_hi:[1,0,0]
    v_fma_mix_f32 v212, v76, 1.0, v193 op_sel_hi:[1,0,0]
    v_fma_mix_f32 v216, v84, 1.0, v194 op_sel_hi:[1,0,0]
    v_fma_mix_f32 v220, v92, 1.0, v195 op_sel_hi:[1,0,0]
    v_fma_mix_f32 v209, v69, 1.0, v196 op_sel_hi:[1,0,0]
    v_fma_mix_f32 v213, v77, 1.0, v197 op_sel_hi:[1,0,0]
    v_fma_mix_f32 v217, v85, 1.0, v198 op_sel_hi:[1,0,0]
    v_fma_mix_f32 v221, v93, 1.0, v199 op_sel_hi:[1,0,0]
    v_fma_mix_f32 v210, v70, 1.0, v200 op_sel_hi:[1,0,0]
    v_fma_mix_f32 v214, v78, 1.0, v201 op_sel_hi:[1,0,0]
    v_fma_mix_f32 v218, v86, 1.0, v202 op_sel_hi:[1,0,0]
    v_fma_mix_f32 v222, v94, 1.0, v203 op_sel_hi:[1,0,0]
    v_fma_mix_f32 v211, v71, 1.0, v204 op_sel_hi:[1,0,0]
    v_fma_mix_f32 v215, v79, 1.0, v205 op_sel_hi:[1,0,0]
    v_fma_mix_f32 v219, v87, 1.0, v206 op_sel_hi:[1,0,0]
    v_fma_mix_f32 v223, v95, 1.0, v207 op_sel_hi:[1,0,0]
    v_exp_f32 v208, v208
    v_mfma_f32_16x16x32_bf16 v[192:195], v[236:239], v[160:163], 0
    v_exp_f32 v209, v209
    v_mfma_f32_16x16x32_bf16 v[196:199], v[236:239], v[164:167], 0
    v_exp_f32 v210, v210
    v_mfma_f32_16x16x32_bf16 v[200:203], v[236:239], v[168:171], 0
    v_exp_f32 v211, v211
    v_mfma_f32_16x16x32_bf16 v[204:207], v[236:239], v[172:175], 0
    v_exp_f32 v212, v212
    v_exp_f32 v213, v213
    v_exp_f32 v214, v214
    v_exp_f32 v215, v215
    v_exp_f32 v216, v216
    v_exp_f32 v217, v217
    v_exp_f32 v218, v218
    v_exp_f32 v219, v219
    v_exp_f32 v220, v220
    v_exp_f32 v221, v221
    v_exp_f32 v222, v222
    v_exp_f32 v223, v223
    v_pk_add_f32 v[208:209], v[208:209], 1.0 op_sel_hi:[1,0]
    v_pk_add_f32 v[210:211], v[210:211], 1.0 op_sel_hi:[1,0]
    v_pk_add_f32 v[212:213], v[212:213], 1.0 op_sel_hi:[1,0]
    v_pk_add_f32 v[214:215], v[214:215], 1.0 op_sel_hi:[1,0]
    v_pk_add_f32 v[216:217], v[216:217], 1.0 op_sel_hi:[1,0]
    v_pk_add_f32 v[218:219], v[218:219], 1.0 op_sel_hi:[1,0]
    v_pk_add_f32 v[220:221], v[220:221], 1.0 op_sel_hi:[1,0]
    v_pk_add_f32 v[222:223], v[222:223], 1.0 op_sel_hi:[1,0]
    v_rcp_f32 v208, v208
    v_rcp_f32 v209, v209
    v_rcp_f32 v210, v210
    v_rcp_f32 v211, v211
    v_rcp_f32 v212, v212
    v_rcp_f32 v213, v213
    v_rcp_f32 v214, v214
    v_rcp_f32 v215, v215
    v_rcp_f32 v216, v216
    v_rcp_f32 v217, v217
    v_rcp_f32 v218, v218
    v_rcp_f32 v219, v219
    v_rcp_f32 v220, v220
    v_rcp_f32 v221, v221
    v_rcp_f32 v222, v222
    v_rcp_f32 v223, v223
    v_pk_mul_f32 v[208:209], v[208:209], v[68:69]
    v_pk_mul_f32 v[210:211], v[210:211], v[70:71]
    v_pk_mul_f32 v[212:213], v[212:213], v[76:77]
    v_pk_mul_f32 v[214:215], v[214:215], v[78:79]
    v_pk_mul_f32 v[216:217], v[216:217], v[84:85]
    v_pk_mul_f32 v[218:219], v[218:219], v[86:87]
    v_pk_mul_f32 v[220:221], v[220:221], v[92:93]
    v_pk_mul_f32 v[222:223], v[222:223], v[94:95]
    v_cvt_pk_bf16_f32 v68, v208, v212
    v_cvt_pk_bf16_f32 v69, v216, v220
    v_cvt_pk_bf16_f32 v76, v209, v213
    v_cvt_pk_bf16_f32 v77, v217, v221
    v_cvt_pk_bf16_f32 v84, v210, v214
    v_cvt_pk_bf16_f32 v85, v218, v222
    v_cvt_pk_bf16_f32 v92, v211, v215
    v_cvt_pk_bf16_f32 v93, v219, v223
    s_waitcnt vmcnt(4)
    v_fma_mix_f32 v208, v96, 1.0, v192 op_sel_hi:[1,0,0]
    v_fma_mix_f32 v209, v97, 1.0, v196 op_sel_hi:[1,0,0]
    v_fma_mix_f32 v210, v98, 1.0, v200 op_sel_hi:[1,0,0]
    v_fma_mix_f32 v211, v99, 1.0, v204 op_sel_hi:[1,0,0]
    s_cmp_le_u32 s59, 1
    s_cbranch_scc1 K2_L12_M2
    v_fma_mix_f32 v212, v104, 1.0, v193 op_sel_hi:[1,0,0]
    v_fma_mix_f32 v213, v105, 1.0, v197 op_sel_hi:[1,0,0]
    v_fma_mix_f32 v214, v106, 1.0, v201 op_sel_hi:[1,0,0]
    v_fma_mix_f32 v215, v107, 1.0, v205 op_sel_hi:[1,0,0]
    s_cmp_le_u32 s59, 2
    s_cbranch_scc1 K2_L12_M2
    v_fma_mix_f32 v216, v112, 1.0, v194 op_sel_hi:[1,0,0]
    v_fma_mix_f32 v217, v113, 1.0, v198 op_sel_hi:[1,0,0]
    v_fma_mix_f32 v218, v114, 1.0, v202 op_sel_hi:[1,0,0]
    v_fma_mix_f32 v219, v115, 1.0, v206 op_sel_hi:[1,0,0]
    s_cmp_le_u32 s59, 3
    s_cbranch_scc1 K2_L12_M2
    v_fma_mix_f32 v220, v120, 1.0, v195 op_sel_hi:[1,0,0]
    v_fma_mix_f32 v221, v121, 1.0, v199 op_sel_hi:[1,0,0]
    v_fma_mix_f32 v222, v122, 1.0, v203 op_sel_hi:[1,0,0]
    v_fma_mix_f32 v223, v123, 1.0, v207 op_sel_hi:[1,0,0]
K2_L12_M2:
    v_exp_f32 v208, v208
    v_mfma_f32_16x16x32_bf16 v[192:195], v[236:239], v[176:179], 0
    v_exp_f32 v209, v209
    v_mfma_f32_16x16x32_bf16 v[196:199], v[236:239], v[180:183], 0
    v_exp_f32 v210, v210
    v_mfma_f32_16x16x32_bf16 v[200:203], v[236:239], v[184:187], 0
    v_exp_f32 v211, v211
    v_mfma_f32_16x16x32_bf16 v[204:207], v[236:239], v[188:191], 0
    v_pk_add_f32 v[208:209], v[208:209], 1.0 op_sel_hi:[1,0]
    v_pk_add_f32 v[210:211], v[210:211], 1.0 op_sel_hi:[1,0]
    v_rcp_f32 v208, v208
    v_rcp_f32 v209, v209
    v_rcp_f32 v210, v210
    v_rcp_f32 v211, v211
    v_pk_mul_f32 v[208:209], v[208:209], v[96:97]
    v_pk_mul_f32 v[210:211], v[210:211], v[98:99]
    s_cmp_le_u32 s59, 1
    s_cbranch_scc1 K2_L12_C2
    v_exp_f32 v212, v212
    v_exp_f32 v213, v213
    v_exp_f32 v214, v214
    v_exp_f32 v215, v215
    v_pk_add_f32 v[212:213], v[212:213], 1.0 op_sel_hi:[1,0]
    v_pk_add_f32 v[214:215], v[214:215], 1.0 op_sel_hi:[1,0]
    v_rcp_f32 v212, v212
    v_rcp_f32 v213, v213
    v_rcp_f32 v214, v214
    v_rcp_f32 v215, v215
    v_pk_mul_f32 v[212:213], v[212:213], v[104:105]
    v_pk_mul_f32 v[214:215], v[214:215], v[106:107]
    s_cmp_le_u32 s59, 2
    s_cbranch_scc1 K2_L12_C2
    v_exp_f32 v216, v216
    v_exp_f32 v217, v217
    v_exp_f32 v218, v218
    v_exp_f32 v219, v219
    v_pk_add_f32 v[216:217], v[216:217], 1.0 op_sel_hi:[1,0]
    v_pk_add_f32 v[218:219], v[218:219], 1.0 op_sel_hi:[1,0]
    v_rcp_f32 v216, v216
    v_rcp_f32 v217, v217
    v_rcp_f32 v218, v218
    v_rcp_f32 v219, v219
    v_pk_mul_f32 v[216:217], v[216:217], v[112:113]
    v_pk_mul_f32 v[218:219], v[218:219], v[114:115]
    s_cmp_le_u32 s59, 3
    s_cbranch_scc1 K2_L12_C2
    v_exp_f32 v220, v220
    v_exp_f32 v221, v221
    v_exp_f32 v222, v222
    v_exp_f32 v223, v223
    v_pk_add_f32 v[220:221], v[220:221], 1.0 op_sel_hi:[1,0]
    v_pk_add_f32 v[222:223], v[222:223], 1.0 op_sel_hi:[1,0]
    v_rcp_f32 v220, v220
    v_rcp_f32 v221, v221
    v_rcp_f32 v222, v222
    v_rcp_f32 v223, v223
    v_pk_mul_f32 v[220:221], v[220:221], v[120:121]
    v_pk_mul_f32 v[222:223], v[222:223], v[122:123]
K2_L12_C2:
    v_cvt_pk_bf16_f32 v66, v208, v212
    v_cvt_pk_bf16_f32 v67, v216, v220
    v_cvt_pk_bf16_f32 v74, v209, v213
    v_cvt_pk_bf16_f32 v75, v217, v221
    v_cvt_pk_bf16_f32 v82, v210, v214
    v_cvt_pk_bf16_f32 v83, v218, v222
    v_cvt_pk_bf16_f32 v90, v211, v215
    v_cvt_pk_bf16_f32 v91, v219, v223
    s_waitcnt lgkmcnt(0)
    s_waitcnt vmcnt(0)
    v_mfma_f32_16x16x32_bf16 v[128:131], v[240:243], v[64:67], v[128:131]
    v_mfma_f32_16x16x32_bf16 v[132:135], v[240:243], v[72:75], v[132:135]
    v_mfma_f32_16x16x32_bf16 v[136:139], v[240:243], v[80:83], v[136:139]
    v_mfma_f32_16x16x32_bf16 v[140:143], v[240:243], v[88:91], v[140:143]
    v_fma_mix_f32 v208, v100, 1.0, v192 op_sel_hi:[1,0,0]
    v_fma_mix_f32 v209, v101, 1.0, v196 op_sel_hi:[1,0,0]
    v_fma_mix_f32 v210, v102, 1.0, v200 op_sel_hi:[1,0,0]
    v_fma_mix_f32 v211, v103, 1.0, v204 op_sel_hi:[1,0,0]
    s_cmp_le_u32 s59, 1
    s_cbranch_scc1 K2_L12_M3
    v_fma_mix_f32 v212, v108, 1.0, v193 op_sel_hi:[1,0,0]
    v_fma_mix_f32 v213, v109, 1.0, v197 op_sel_hi:[1,0,0]
    v_fma_mix_f32 v214, v110, 1.0, v201 op_sel_hi:[1,0,0]
    v_fma_mix_f32 v215, v111, 1.0, v205 op_sel_hi:[1,0,0]
    s_cmp_le_u32 s59, 2
    s_cbranch_scc1 K2_L12_M3
    v_fma_mix_f32 v216, v116, 1.0, v194 op_sel_hi:[1,0,0]
    v_fma_mix_f32 v217, v117, 1.0, v198 op_sel_hi:[1,0,0]
    v_fma_mix_f32 v218, v118, 1.0, v202 op_sel_hi:[1,0,0]
    v_fma_mix_f32 v219, v119, 1.0, v206 op_sel_hi:[1,0,0]
    s_cmp_le_u32 s59, 3
    s_cbranch_scc1 K2_L12_M3
    v_fma_mix_f32 v220, v124, 1.0, v195 op_sel_hi:[1,0,0]
    v_fma_mix_f32 v221, v125, 1.0, v199 op_sel_hi:[1,0,0]
    v_fma_mix_f32 v222, v126, 1.0, v203 op_sel_hi:[1,0,0]
    v_fma_mix_f32 v223, v127, 1.0, v207 op_sel_hi:[1,0,0]
K2_L12_M3:
    v_exp_f32 v208, v208
    v_exp_f32 v209, v209
    v_exp_f32 v210, v210
    v_exp_f32 v211, v211
    v_pk_add_f32 v[208:209], v[208:209], 1.0 op_sel_hi:[1,0]
    v_pk_add_f32 v[210:211], v[210:211], 1.0 op_sel_hi:[1,0]
    v_rcp_f32 v208, v208
    v_rcp_f32 v209, v209
    v_rcp_f32 v210, v210
    v_rcp_f32 v211, v211
    v_pk_mul_f32 v[208:209], v[208:209], v[100:101]
    v_pk_mul_f32 v[210:211], v[210:211], v[102:103]
    s_cmp_le_u32 s59, 1
    s_cbranch_scc1 K2_L12_C3
    v_exp_f32 v212, v212
    v_exp_f32 v213, v213
    v_exp_f32 v214, v214
    v_exp_f32 v215, v215
    v_pk_add_f32 v[212:213], v[212:213], 1.0 op_sel_hi:[1,0]
    v_pk_add_f32 v[214:215], v[214:215], 1.0 op_sel_hi:[1,0]
    v_rcp_f32 v212, v212
    v_rcp_f32 v213, v213
    v_rcp_f32 v214, v214
    v_rcp_f32 v215, v215
    v_pk_mul_f32 v[212:213], v[212:213], v[108:109]
    v_pk_mul_f32 v[214:215], v[214:215], v[110:111]
    s_cmp_le_u32 s59, 2
    s_cbranch_scc1 K2_L12_C3
    v_exp_f32 v216, v216
    v_exp_f32 v217, v217
    v_exp_f32 v218, v218
    v_exp_f32 v219, v219
    v_pk_add_f32 v[216:217], v[216:217], 1.0 op_sel_hi:[1,0]
    v_pk_add_f32 v[218:219], v[218:219], 1.0 op_sel_hi:[1,0]
    v_rcp_f32 v216, v216
    v_rcp_f32 v217, v217
    v_rcp_f32 v218, v218
    v_rcp_f32 v219, v219
    v_pk_mul_f32 v[216:217], v[216:217], v[116:117]
    v_pk_mul_f32 v[218:219], v[218:219], v[118:119]
    s_cmp_le_u32 s59, 3
    s_cbranch_scc1 K2_L12_C3
    v_exp_f32 v220, v220
    v_exp_f32 v221, v221
    v_exp_f32 v222, v222
    v_exp_f32 v223, v223
    v_pk_add_f32 v[220:221], v[220:221], 1.0 op_sel_hi:[1,0]
    v_pk_add_f32 v[222:223], v[222:223], 1.0 op_sel_hi:[1,0]
    v_rcp_f32 v220, v220
    v_rcp_f32 v221, v221
    v_rcp_f32 v222, v222
    v_rcp_f32 v223, v223
    v_pk_mul_f32 v[220:221], v[220:221], v[124:125]
    v_pk_mul_f32 v[222:223], v[222:223], v[126:127]
K2_L12_C3:
    v_cvt_pk_bf16_f32 v70, v208, v212
    v_cvt_pk_bf16_f32 v71, v216, v220
    v_cvt_pk_bf16_f32 v78, v209, v213
    v_cvt_pk_bf16_f32 v79, v217, v221
    v_cvt_pk_bf16_f32 v86, v210, v214
    v_cvt_pk_bf16_f32 v87, v218, v222
    v_cvt_pk_bf16_f32 v94, v211, v215
    v_cvt_pk_bf16_f32 v95, v219, v223
    s_waitcnt lgkmcnt(0)
    s_nop 0
    v_mfma_f32_16x16x32_bf16 v[144:147], v[240:243], v[68:71], v[144:147]
    v_mfma_f32_16x16x32_bf16 v[148:151], v[240:243], v[76:79], v[148:151]
    v_mfma_f32_16x16x32_bf16 v[152:155], v[240:243], v[84:87], v[152:155]
    v_mfma_f32_16x16x32_bf16 v[156:159], v[240:243], v[92:95], v[156:159]
    s_branch K2_TDONE
K2_HALF1:
    ds_read2_b32 v[240:241], v249 offset0:32 offset1:48
    s_waitcnt vmcnt(12)
    v_fma_mix_f32 v208, v64, 1.0, v192 op_sel_hi:[1,0,0]
    v_fma_mix_f32 v209, v65, 1.0, v196 op_sel_hi:[1,0,0]
    v_fma_mix_f32 v210, v66, 1.0, v200 op_sel_hi:[1,0,0]
    v_fma_mix_f32 v211, v67, 1.0, v204 op_sel_hi:[1,0,0]
    s_cmp_le_u32 s59, 1
    s_cbranch_scc1 K2_L11_M0
    v_fma_mix_f32 v212, v72, 1.0, v193 op_sel_hi:[1,0,0]
    v_fma_mix_f32 v213, v73, 1.0, v197 op_sel_hi:[1,0,0]
    v_fma_mix_f32 v214, v74, 1.0, v201 op_sel_hi:[1,0,0]
    v_fma_mix_f32 v215, v75, 1.0, v205 op_sel_hi:[1,0,0]
    s_cmp_le_u32 s59, 2
    s_cbranch_scc1 K2_L11_M0
    v_fma_mix_f32 v216, v80, 1.0, v194 op_sel_hi:[1,0,0]
    v_fma_mix_f32 v217, v81, 1.0, v198 op_sel_hi:[1,0,0]
    v_fma_mix_f32 v218, v82, 1.0, v202 op_sel_hi:[1,0,0]
    v_fma_mix_f32 v219, v83, 1.0, v206 op_sel_hi:[1,0,0]
    s_cmp_le_u32 s59, 3
    s_cbranch_scc1 K2_L11_M0
    v_fma_mix_f32 v220, v88, 1.0, v195 op_sel_hi:[1,0,0]
    v_fma_mix_f32 v221, v89, 1.0, v199 op_sel_hi:[1,0,0]
    v_fma_mix_f32 v222, v90, 1.0, v203 op_sel_hi:[1,0,0]
    v_fma_mix_f32 v223, v91, 1.0, v207 op_sel_hi:[1,0,0]
K2_L11_M0:
    s_waitcnt lgkmcnt(0)
    v_and_or_b32 v242, v241, s54, v246
    v_and_or_b32 v240, v240, s54, v246
    ds_read_b64_tr_b16 v[242:243], v242
    ds_read_b64_tr_b16 v[240:241], v240
    v_exp_f32 v208, v208
    v_mfma_f32_16x16x32_bf16 v[192:195], v[232:235], v[176:179], 0
    v_exp_f32 v209, v209
    v_mfma_f32_16x16x32_bf16 v[196:199], v[232:235], v[180:183], 0
    v_exp_f32 v210, v210
    v_mfma_f32_16x16x32_bf16 v[200:203], v[232:235], v[184:187], 0
    v_exp_f32 v211, v211
    v_mfma_f32_16x16x32_bf16 v[204:207], v[232:235], v[188:191], 0
    v_pk_add_f32 v[208:209], v[208:209], 1.0 op_sel_hi:[1,0]
    v_pk_add_f32 v[210:211], v[210:211], 1.0 op_sel_hi:[1,0]
    v_rcp_f32 v208, v208
    v_rcp_f32 v209, v209
    v_rcp_f32 v210, v210
    v_rcp_f32 v211, v211
    v_pk_mul_f32 v[208:209], v[208:209], v[64:65]
    v_pk_mul_f32 v[210:211], v[210:211], v[66:67]
    s_cmp_le_u32 s59, 1
    s_cbranch_scc1 K2_L11_C0
    v_exp_f32 v212, v212
    v_exp_f32 v213, v213
    v_exp_f32 v214, v214
    v_exp_f32 v215, v215
    v_pk_add_f32 v[212:213], v[212:213], 1.0 op_sel_hi:[1,0]
    v_pk_add_f32 v[214:215], v[214:215], 1.0 op_sel_hi:[1,0]
    v_rcp_f32 v212, v212
    v_rcp_f32 v213, v213
    v_rcp_f32 v214, v214
    v_rcp_f32 v215, v215
    v_pk_mul_f32 v[212:213], v[212:213], v[72:73]
    v_pk_mul_f32 v[214:215], v[214:215], v[74:75]
    s_cmp_le_u32 s59, 2
    s_cbranch_scc1 K2_L11_C0
    v_exp_f32 v216, v216
    v_exp_f32 v217, v217
    v_exp_f32 v218, v218
    v_exp_f32 v219, v219
    v_pk_add_f32 v[216:217], v[216:217], 1.0 op_sel_hi:[1,0]
    v_pk_add_f32 v[218:219], v[218:219], 1.0 op_sel_hi:[1,0]
    v_rcp_f32 v216, v216
    v_rcp_f32 v217, v217
    v_rcp_f32 v218, v218
    v_rcp_f32 v219, v219
    v_pk_mul_f32 v[216:217], v[216:217], v[80:81]
    v_pk_mul_f32 v[218:219], v[218:219], v[82:83]
    s_cmp_le_u32 s59, 3
    s_cbranch_scc1 K2_L11_C0
    v_exp_f32 v220, v220
    v_exp_f32 v221, v221
    v_exp_f32 v222, v222
    v_exp_f32 v223, v223
    v_pk_add_f32 v[220:221], v[220:221], 1.0 op_sel_hi:[1,0]
    v_pk_add_f32 v[222:223], v[222:223], 1.0 op_sel_hi:[1,0]
    v_rcp_f32 v220, v220
    v_rcp_f32 v221, v221
    v_rcp_f32 v222, v222
    v_rcp_f32 v223, v223
    v_pk_mul_f32 v[220:221], v[220:221], v[88:89]
    v_pk_mul_f32 v[222:223], v[222:223], v[90:91]
K2_L11_C0:
    v_cvt_pk_bf16_f32 v64, v208, v212
    v_cvt_pk_bf16_f32 v65, v216, v220
    v_cvt_pk_bf16_f32 v72, v209, v213
    v_cvt_pk_bf16_f32 v73, v217, v221
    v_cvt_pk_bf16_f32 v80, v210, v214
    v_cvt_pk_bf16_f32 v81, v218, v222
    v_cvt_pk_bf16_f32 v88, v211, v215
    v_cvt_pk_bf16_f32 v89, v219, v223
    s_waitcnt lgkmcnt(0)
    s_waitcnt vmcnt(8)
    v_mfma_f32_16x16x16_bf16 v[128:131], v[240:241], v[64:65], v[128:131]
    v_mfma_f32_16x16x16_bf16 v[132:135], v[240:241], v[72:73], v[132:135]
    v_mfma_f32_16x16x16_bf16 v[136:139], v[240:241], v[80:81], v[136:139]
    v_mfma_f32_16x16x16_bf16 v[140:143], v[240:241], v[88:89], v[140:143]
    v_fma_mix_f32 v208, v68, 1.0, v192 op_sel_hi:[1,0,0]
    v_fma_mix_f32 v209, v69, 1.0, v196 op_sel_hi:[1,0,0]
    v_fma_mix_f32 v210, v70, 1.0, v200 op_sel_hi:[1,0,0]
    v_fma_mix_f32 v211, v71, 1.0, v204 op_sel_hi:[1,0,0]
    s_cmp_le_u32 s59, 1
    s_cbranch_scc1 K2_L11_M1
    v_fma_mix_f32 v212, v76, 1.0, v193 op_sel_hi:[1,0,0]
    v_fma_mix_f32 v213, v77, 1.0, v197 op_sel_hi:[1,0,0]
    v_fma_mix_f32 v214, v78, 1.0, v201 op_sel_hi:[1,0,0]
    v_fma_mix_f32 v215, v79, 1.0, v205 op_sel_hi:[1,0,0]
    s_cmp_le_u32 s59, 2
    s_cbranch_scc1 K2_L11_M1
    v_fma_mix_f32 v216, v84, 1.0, v194 op_sel_hi:[1,0,0]
    v_fma_mix_f32 v217, v85, 1.0, v198 op_sel_hi:[1,0,0]
    v_fma_mix_f32 v218, v86, 1.0, v202 op_sel_hi:[1,0,0]
    v_fma_mix_f32 v219, v87, 1.0, v206 op_sel_hi:[1,0,0]
    s_cmp_le_u32 s59, 3
    s_cbranch_scc1 K2_L11_M1
    v_fma_mix_f32 v220, v92, 1.0, v195 op_sel_hi:[1,0,0]
    v_fma_mix_f32 v221, v93, 1.0, v199 op_sel_hi:[1,0,0]
    v_fma_mix_f32 v222, v94, 1.0, v203 op_sel_hi:[1,0,0]
    v_fma_mix_f32 v223, v95, 1.0, v207 op_sel_hi:[1,0,0]
K2_L11_M1:
    v_exp_f32 v208, v208
    v_exp_f32 v209, v209
    v_exp_f32 v210, v210
    v_exp_f32 v211, v211
    v_pk_add_f32 v[208:209], v[208:209], 1.0 op_sel_hi:[1,0]
    v_pk_add_f32 v[210:211], v[210:211], 1.0 op_sel_hi:[1,0]
    v_rcp_f32 v208, v208
    v_rcp_f32 v209, v209
    v_rcp_f32 v210, v210
    v_rcp_f32 v211, v211
    v_pk_mul_f32 v[208:209], v[208:209], v[68:69]
    v_pk_mul_f32 v[210:211], v[210:211], v[70:71]
    s_cmp_le_u32 s59, 1
    s_cbranch_scc1 K2_L11_C1
    v_exp_f32 v212, v212
    v_exp_f32 v213, v213
    v_exp_f32 v214, v214
    v_exp_f32 v215, v215
    v_pk_add_f32 v[212:213], v[212:213], 1.0 op_sel_hi:[1,0]
    v_pk_add_f32 v[214:215], v[214:215], 1.0 op_sel_hi:[1,0]
    v_rcp_f32 v212, v212
    v_rcp_f32 v213, v213
    v_rcp_f32 v214, v214
    v_rcp_f32 v215, v215
    v_pk_mul_f32 v[212:213], v[212:213], v[76:77]
    v_pk_mul_f32 v[214:215], v[214:215], v[78:79]
    s_cmp_le_u32 s59, 2
    s_cbranch_scc1 K2_L11_C1
    v_exp_f32 v216, v216
    v_exp_f32 v217, v217
    v_exp_f32 v218, v218
    v_exp_f32 v219, v219
    v_pk_add_f32 v[216:217], v[216:217], 1.0 op_sel_hi:[1,0]
    v_pk_add_f32 v[218:219], v[218:219], 1.0 op_sel_hi:[1,0]
    v_rcp_f32 v216, v216
    v_rcp_f32 v217, v217
    v_rcp_f32 v218, v218
    v_rcp_f32 v219, v219
    v_pk_mul_f32 v[216:217], v[216:217], v[84:85]
    v_pk_mul_f32 v[218:219], v[218:219], v[86:87]
    s_cmp_le_u32 s59, 3
    s_cbranch_scc1 K2_L11_C1
    v_exp_f32 v220, v220
    v_exp_f32 v221, v221
    v_exp_f32 v222, v222
    v_exp_f32 v223, v223
    v_pk_add_f32 v[220:221], v[220:221], 1.0 op_sel_hi:[1,0]
    v_pk_add_f32 v[222:223], v[222:223], 1.0 op_sel_hi:[1,0]
    v_rcp_f32 v220, v220
    v_rcp_f32 v221, v221
    v_rcp_f32 v222, v222
    v_rcp_f32 v223, v223
    v_pk_mul_f32 v[220:221], v[220:221], v[92:93]
    v_pk_mul_f32 v[222:223], v[222:223], v[94:95]
K2_L11_C1:
    v_cvt_pk_bf16_f32 v68, v208, v212
    v_cvt_pk_bf16_f32 v69, v216, v220
    v_cvt_pk_bf16_f32 v76, v209, v213
    v_cvt_pk_bf16_f32 v77, v217, v221
    v_cvt_pk_bf16_f32 v84, v210, v214
    v_cvt_pk_bf16_f32 v85, v218, v222
    v_cvt_pk_bf16_f32 v92, v211, v215
    v_cvt_pk_bf16_f32 v93, v219, v223
    s_waitcnt lgkmcnt(0)
    s_nop 0
    v_mfma_f32_16x16x16_bf16 v[144:147], v[240:241], v[68:69], v[144:147]
    v_mfma_f32_16x16x16_bf16 v[148:151], v[240:241], v[76:77], v[148:151]
    v_mfma_f32_16x16x16_bf16 v[152:155], v[240:241], v[84:85], v[152:155]
    v_mfma_f32_16x16x16_bf16 v[156:159], v[240:241], v[92:93], v[156:159]
K2_TDONE:
    s_waitcnt vmcnt(0) lgkmcnt(0)
    s_mov_b32 s42, 0
    s_cmp_lg_u32 s48, 0
    s_cbranch_scc1 K2_AGAIN
    s_add_u32 s40, s40, s41
    s_cmp_ge_u32 s40, 256
    s_cbranch_scc1 K2_EPI
K2_AGAIN:
    s_setprio 0
    s_waitcnt lgkmcnt(0)
    s_barrier
    v_and_b32 v2, 63, v250
    v_lshlrev_b32 v3, 4, v2
    v_mov_b32 v4, 0
    v_mov_b32 v5, 0
    v_mov_b32 v6, 0
    v_mov_b32 v7, 0
    ds_write_b128 v3, v[4:7] offset:0
    ds_write_b32 v4, v4 offset:3072
    s_waitcnt lgkmcnt(0)
    s_barrier
    s_branch K2_ROUND
K2_EPI:
    s_mul_i32 s53, s43, 49
    s_add_u32 s53, s53, 51
    s_lshr_b32 s53, s53, 2
    s_sub_u32 s53, s53, s52
    v_and_b32 v2, 63, v250
    v_lshrrev_b32 v3, 4, v2
    v_lshlrev_b32 v3, 2, v3
    v_and_b32 v4, 15, v2
    v_add_u32 v5, s52, v3
    v_lshlrev_b32 v5, 8, v5
    v_lshl_add_u32 v5, v4, 3, v5
    s_mov_b32 s36, 3216550459
    s_mov_b32 s37, 3216550459
    v_mov_b32 v6, 0x7ffffff0
    v_add_u32 v7, 0, v3
    v_cmp_gt_u32 vcc, s53, v7
    s_nop 1
    v_cndmask_b32 v8, v6, v5, vcc
    v_add_u32 v7, 1, v3
    v_cmp_gt_u32 vcc, s53, v7
    s_nop 1
    v_cndmask_b32 v9, v6, v5, vcc
    v_add_u32 v7, 2, v3
    v_cmp_gt_u32 vcc, s53, v7
    s_nop 1
    v_cndmask_b32 v10, v6, v5, vcc
    v_add_u32 v7, 3, v3
    v_cmp_gt_u32 vcc, s53, v7
    s_nop 1
    v_cndmask_b32 v11, v6, v5, vcc
    v_pk_mul_f32 v[16:17], v[128:129], s[36:37]
    v_pk_mul_f32 v[18:19], v[130:131], s[36:37]
    v_pk_mul_f32 v[20:21], v[132:133], s[36:37]
    v_pk_mul_f32 v[22:23], v[134:135], s[36:37]
    v_pk_mul_f32 v[24:25], v[136:137], s[36:37]
    v_pk_mul_f32 v[26:27], v[138:139], s[36:37]
    v_pk_mul_f32 v[28:29], v[140:141], s[36:37]
    v_pk_mul_f32 v[30:31], v[142:143], s[36:37]
    v_exp_f32 v16, v16
    v_exp_f32 v17, v17
    v_exp_f32 v18, v18
    v_exp_f32 v19, v19
    v_exp_f32 v20, v20
    v_exp_f32 v21, v21
    v_exp_f32 v22, v22
    v_exp_f32 v23, v23
    v_exp_f32 v24, v24
    v_exp_f32 v25, v25
    v_exp_f32 v26, v26
    v_exp_f32 v27, v27
    v_exp_f32 v28, v28
    v_exp_f32 v29, v29
    v_exp_f32 v30, v30
    v_exp_f32 v31, v31
    v_pk_add_f32 v[16:17], v[16:17], 1.0 op_sel_hi:[1,0]
    v_pk_add_f32 v[18:19], v[18:19], 1.0 op_sel_hi:[1,0]
    v_pk_add_f32 v[20:21], v[20:21], 1.0 op_sel_hi:[1,0]
    v_pk_add_f32 v[22:23], v[22:23], 1.0 op_sel_hi:[1,0]
    v_pk_add_f32 v[24:25], v[24:25], 1.0 op_sel_hi:[1,0]
    v_pk_add_f32 v[26:27], v[26:27], 1.0 op_sel_hi:[1,0]
    v_pk_add_f32 v[28:29], v[28:29], 1.0 op_sel_hi:[1,0]
    v_pk_add_f32 v[30:31], v[30:31], 1.0 op_sel_hi:[1,0]
    v_rcp_f32 v16, v16
    v_rcp_f32 v17, v17
    v_rcp_f32 v18, v18
    v_rcp_f32 v19, v19
    v_rcp_f32 v20, v20
    v_rcp_f32 v21, v21
    v_rcp_f32 v22, v22
    v_rcp_f32 v23, v23
    v_rcp_f32 v24, v24
    v_rcp_f32 v25, v25
    v_rcp_f32 v26, v26
    v_rcp_f32 v27, v27
    v_rcp_f32 v28, v28
    v_rcp_f32 v29, v29
    v_rcp_f32 v30, v30
    v_rcp_f32 v31, v31
    v_pk_mul_f32 v[16:17], v[16:17], v[128:129]
    v_pk_mul_f32 v[18:19], v[18:19], v[130:131]
    v_pk_mul_f32 v[20:21], v[20:21], v[132:133]
    v_pk_mul_f32 v[22:23], v[22:23], v[134:135]
    v_pk_mul_f32 v[24:25], v[24:25], v[136:137]
    v_pk_mul_f32 v[26:27], v[26:27], v[138:139]
    v_pk_mul_f32 v[28:29], v[28:29], v[140:141]
    v_pk_mul_f32 v[30:31], v[30:31], v[142:143]
    v_cvt_pk_bf16_f32 v48, v16, v20
    v_cvt_pk_bf16_f32 v49, v24, v28
    buffer_store_dwordx2 v[48:49], v8, s[28:31], 0 offen offset:0 sc1
    v_cvt_pk_bf16_f32 v52, v17, v21
    v_cvt_pk_bf16_f32 v53, v25, v29
    buffer_store_dwordx2 v[52:53], v9, s[28:31], 0 offen offset:256 sc1
    v_cvt_pk_bf16_f32 v56, v18, v22
    v_cvt_pk_bf16_f32 v57, v26, v30
    buffer_store_dwordx2 v[56:57], v10, s[28:31], 0 offen offset:512 sc1
    v_cvt_pk_bf16_f32 v60, v19, v23
    v_cvt_pk_bf16_f32 v61, v27, v31
    buffer_store_dwordx2 v[60:61], v11, s[28:31], 0 offen offset:768 sc1
    v_pk_mul_f32 v[32:33], v[144:145], s[36:37]
    v_pk_mul_f32 v[34:35], v[146:147], s[36:37]
    v_pk_mul_f32 v[36:37], v[148:149], s[36:37]
    v_pk_mul_f32 v[38:39], v[150:151], s[36:37]
    v_pk_mul_f32 v[40:41], v[152:153], s[36:37]
    v_pk_mul_f32 v[42:43], v[154:155], s[36:37]
    v_pk_mul_f32 v[44:45], v[156:157], s[36:37]
    v_pk_mul_f32 v[46:47], v[158:159], s[36:37]
    v_exp_f32 v32, v32
    v_exp_f32 v33, v33
    v_exp_f32 v34, v34
    v_exp_f32 v35, v35
    v_exp_f32 v36, v36
    v_exp_f32 v37, v37
    v_exp_f32 v38, v38
    v_exp_f32 v39, v39
    v_exp_f32 v40, v40
    v_exp_f32 v41, v41
    v_exp_f32 v42, v42
    v_exp_f32 v43, v43
    v_exp_f32 v44, v44
    v_exp_f32 v45, v45
    v_exp_f32 v46, v46
    v_exp_f32 v47, v47
    v_pk_add_f32 v[32:33], v[32:33], 1.0 op_sel_hi:[1,0]
    v_pk_add_f32 v[34:35], v[34:35], 1.0 op_sel_hi:[1,0]
    v_pk_add_f32 v[36:37], v[36:37], 1.0 op_sel_hi:[1,0]
    v_pk_add_f32 v[38:39], v[38:39], 1.0 op_sel_hi:[1,0]
    v_pk_add_f32 v[40:41], v[40:41], 1.0 op_sel_hi:[1,0]
    v_pk_add_f32 v[42:43], v[42:43], 1.0 op_sel_hi:[1,0]
    v_pk_add_f32 v[44:45], v[44:45], 1.0 op_sel_hi:[1,0]
    v_pk_add_f32 v[46:47], v[46:47], 1.0 op_sel_hi:[1,0]
    v_rcp_f32 v32, v32
    v_rcp_f32 v33, v33
    v_rcp_f32 v34, v34
    v_rcp_f32 v35, v35
    v_rcp_f32 v36, v36
    v_rcp_f32 v37, v37
    v_rcp_f32 v38, v38
    v_rcp_f32 v39, v39
    v_rcp_f32 v40, v40
    v_rcp_f32 v41, v41
    v_rcp_f32 v42, v42
    v_rcp_f32 v43, v43
    v_rcp_f32 v44, v44
    v_rcp_f32 v45, v45
    v_rcp_f32 v46, v46
    v_rcp_f32 v47, v47
    v_pk_mul_f32 v[32:33], v[32:33], v[144:145]
    v_pk_mul_f32 v[34:35], v[34:35], v[146:147]
    v_pk_mul_f32 v[36:37], v[36:37], v[148:149]
    v_pk_mul_f32 v[38:39], v[38:39], v[150:151]
    v_pk_mul_f32 v[40:41], v[40:41], v[152:153]
    v_pk_mul_f32 v[42:43], v[42:43], v[154:155]
    v_pk_mul_f32 v[44:45], v[44:45], v[156:157]
    v_pk_mul_f32 v[46:47], v[46:47], v[158:159]
    v_cvt_pk_bf16_f32 v50, v32, v36
    v_cvt_pk_bf16_f32 v51, v40, v44
    buffer_store_dwordx2 v[50:51], v8, s[28:31], 0 offen offset:128 sc1
    v_cvt_pk_bf16_f32 v54, v33, v37
    v_cvt_pk_bf16_f32 v55, v41, v45
    buffer_store_dwordx2 v[54:55], v9, s[28:31], 0 offen offset:384 sc1
    v_cvt_pk_bf16_f32 v58, v34, v38
    v_cvt_pk_bf16_f32 v59, v42, v46
    buffer_store_dwordx2 v[58:59], v10, s[28:31], 0 offen offset:640 sc1
    v_cvt_pk_bf16_f32 v62, v35, v39
    v_cvt_pk_bf16_f32 v63, v43, v47
    buffer_store_dwordx2 v[62:63], v11, s[28:31], 0 offen offset:896 sc1
K_END:
    s_endpgm
.p2align 8
.fill 256, 4, 0xbf810000
.section .rodata,"a"
.p2align 6
.amdhsa_kernel standalone__edge_featured_mpnn_egc__graph_kernel
  .amdhsa_next_free_vgpr 256
  .amdhsa_next_free_sgpr 102
  .amdhsa_accum_offset 256
  .amdhsa_group_segment_fixed_size 0
  .amdhsa_kernarg_size 80
  .amdhsa_user_sgpr_count 2
  .amdhsa_user_sgpr_kernarg_segment_ptr 1
  .amdhsa_system_sgpr_workgroup_id_x 1
.end_amdhsa_kernel
```
